```python
import torch

def _softmax(x, axis=-1):
    return torch.softmax(x, dim=axis)
def _gelu(x):
    return torch.nn.functional.gelu(x, approximate="tanh")
def _silu(x):
    return torch.nn.functional.silu(x)
def _sigmoid(x):
    return torch.sigmoid(x)
def _layernorm(x, axis=-1, eps=1e-5):
    m = x.mean(dim=axis, keepdim=True)
    v = x.var(dim=axis, keepdim=True, unbiased=False)
    return (x - m) / torch.sqrt(v + eps)
def _scatter_add(tgt, idx, src, axis=0):
    return tgt.clone().index_add_(axis, idx, src)
def _segment_sum(src, seg, n):
    out = torch.zeros((n,) + src.shape[1:], dtype=src.dtype)
    return out.index_add_(0, seg, src)
def _pad(x, pw):
    flat = tuple(v for pair in reversed(pw) for v in pair)
    return torch.nn.functional.pad(x, flat)

kernel_name = 'standalone__edge_featured_mpnn_mpnn__graph'

def setup_inputs():

    _w = (lambda a: (lambda t: t.to(torch.bfloat16) if t.is_floating_point() else t)(torch.as_tensor(a)))
    N, deg, D, De = 25000, 32, 64, max(4, 1)
    E = N * deg
    H = 2 * D
    return {
        "x": _w((lambda *s: torch.randn(*s, dtype=torch.bfloat16) * 0.05)(N, D)),
        "e_attr": _w((lambda *s: torch.randn(*s, dtype=torch.bfloat16) * 1.6)(E, De)),
        "src": _w((lambda lo, hi, *s: torch.randint(lo, hi, s))(0, N, E).to(torch.int64)),
        "dst": _w((lambda lo, hi, *s: torch.randint(lo, hi, s))(0, N, E).to(torch.int64)),
        "w1": _w((lambda *s: torch.randn(*s, dtype=torch.bfloat16) * 1.6)(2 * D + De, H) * (1.0 / (2 * D + De) ** 0.5)),
        "b1": _w((lambda *s: torch.randn(*s, dtype=torch.bfloat16) * 3.2)(H) * 0.01),
        "w2": _w((lambda *s: torch.randn(*s, dtype=torch.bfloat16) * 0.05)(H, D) * (1.0 / H ** 0.5)),
        "b2": _w((lambda *s: torch.randn(*s, dtype=torch.bfloat16) * 0.1)(D) * 0.01),
    }

def reference(x, e_attr, src, dst, w1, b1, w2, b2):
    N, D = x.shape
    h_src = x[src]
    h_dst = x[dst]
    m_in = torch.concatenate([h_src, h_dst, e_attr], axis=-1)
    h = _silu(m_in @ w1 + b1)
    msg = h @ w2 + b2
    return _segment_sum(msg, dst, N)
```

```asm
; @launch grid=(256,1,1) block=(768,1,1) lds=162064
.amdgcn_target "amdgcn-amd-amdhsa--gfx950"
.text
.globl standalone__edge_featured_mpnn_mpnn__graph_kernel
.p2align 8
.type standalone__edge_featured_mpnn_mpnn__graph_kernel,@function
standalone__edge_featured_mpnn_mpnn__graph_kernel:
    s_cmp_ge_u32 s2, 256
    s_cbranch_scc1 L_exit
    s_load_dwordx16 s[32:47], s[0:1], 0
    s_load_dwordx2 s[48:49], s[0:1], 64
    s_load_dwordx2 s[50:51], s[0:1], 80
    v_lshrrev_b32 v40, 6, v0
    v_and_b32 v1, 63, v0
    v_readfirstlane_b32 s63, v40
    s_getpc_b64 s[94:95]
    s_lshr_b32 s98, s2, 3
    s_mul_i32 s98, s98, 12
    s_add_u32 s98, s98, s63
    s_and_b32 s98, s98, 255
    s_lshl_b32 s98, s98, 6
    s_mul_i32 s88, s2, 12288
    s_lshl_b32 s89, s63, 10
    s_add_u32 s88, s88, s89
    v_lshl_add_u32 v41, v1, 3, s88
    v_lshlrev_b32 v42, 1, v41
    s_and_b32 s62, s2, 7
    s_lshl_b32 s62, s62, 5
    s_lshr_b32 s89, s2, 3
    s_add_u32 s62, s62, s89
    v_lshlrev_b32 v75, 2, v0
    v_mov_b32 v76, 0
    ds_write_b32 v75, v76 offset:1600
    v_lshrrev_b32 v68, 3, v1
    v_lshrrev_b32 v69, 4, v1
    v_and_b32 v70, 7, v1
    v_xor_b32 v70, v70, v69
    v_lshlrev_b32 v70, 4, v70
    v_lshl_add_u32 v70, v68, 7, v70
    s_and_b32 s88, s63, 1
    s_lshl_b32 s88, s88, 6
    v_xor_b32 v71, s88, v70
    v_and_b32 v72, 15, v1
    v_lshlrev_b32 v73, 2, v69
    v_xor_b32 v72, v72, v73
    v_lshlrev_b32 v72, 4, v72
    v_lshl_add_u32 v72, v69, 8, v72
    v_lshlrev_b32 v74, 1, v1
    v_and_b32 v75, 32, v1
    v_lshl_add_u32 v74, v75, 4, v74
    v_lshlrev_b32 v45, 4, v1
    v_lshlrev_b32 v40, 4, v0
    s_mul_i32 s89, s62, 12544
    s_lshl_b32 s90, s63, 10
    s_mov_b32 s18, 3200000
    s_mov_b32 s19, 0x00020000
    s_mov_b32 s22, 33792
    s_mov_b32 s23, 0x00020000
    s_mov_b32 s26, 256
    s_mov_b32 s27, 0x00020000
    s_mov_b32 s30, 16384
    s_mov_b32 s31, 0x00020000
    s_waitcnt lgkmcnt(0)
    s_add_u32 s50, s50, 0
    s_addc_u32 s51, s51, 0
    s_load_dword s3, s[94:95], s98
    s_load_dword s72, s[50:51], 0
    s_mov_b32 s16, s32
    s_and_b32 s17, s33, 0xffff
    s_mov_b32 s20, s40
    s_and_b32 s21, s41, 0xffff
    s_mov_b32 s24, s42
    s_and_b32 s25, s43, 0xffff
    s_mov_b32 s28, s44
    s_and_b32 s29, s45, 0xffff
    s_cmp_ge_u32 s63, 8
    s_cbranch_scc1 L_opt_hi
    s_add_u32 s91, s90, 24576
    s_add_u32 m0, s91, 76032
    s_cmp_lg_u32 s63, 0
    buffer_load_dwordx4 v72, s[20:23], s91 offen lds
    s_cbranch_scc1 L_opt_end
    s_mov_b32 m0, 59392
    s_add_u32 s91, s89, 12288
    buffer_load_dwordx4 v70, s[16:19], s91 offen  lds
    s_branch L_opt_end
L_opt_hi:
    s_cmp_lg_u32 s63, 9
    s_cbranch_scc1 L_opt_a
    s_mul_i32 s88, s2, 53
    s_add_u32 s88, s88, 786432
    v_add_lshl_u32 v43, v1, s88, 2
    v_lshlrev_b32 v44, 1, v43
    s_mov_b32 exec_lo, 4294967295
    s_mov_b32 exec_hi, 2097151
    global_load_dword v64, v43, s[38:39]
    global_load_dword v65, v43, s[36:37]
    global_load_dwordx2 v[66:67], v44, s[34:35]
    s_mov_b64 exec, -1
    s_branch L_opt_end
L_opt_a:
    s_cmp_lg_u32 s63, 10
    s_cbranch_scc1 L_opt_end
    s_mov_b32 s88, 32768
    buffer_load_dwordx4 v[12:15], v45, s[20:23], s88 offen
L_opt_end:
    global_load_dwordx2 v[48:49], v41, s[38:39]
    global_load_dwordx2 v[50:51], v41, s[38:39] offset:512
    s_add_u32 m0, s90, 47104
    s_add_u32 s91, s89, s90
    buffer_load_dwordx4 v71, s[16:19], s91 offen  lds
    s_add_u32 m0, s90, 76032
    s_add_u32 s91, s90, 12288
    buffer_load_dwordx4 v72, s[20:23], s90 offen lds
    s_add_u32 m0, s91, 76032
    s_nop 0
    buffer_load_dwordx4 v72, s[20:23], s91 offen lds
    s_barrier
    global_load_dwordx2 v[52:53], v41, s[36:37]
    global_load_dwordx2 v[54:55], v41, s[36:37] offset:512
    global_load_dwordx4 v[56:59], v42, s[34:35]
    global_load_dwordx4 v[60:63], v42, s[34:35] offset:1024
    s_and_b32 s88, s63, 1
    s_lshl_b32 s88, s88, 7
    buffer_load_ushort v160, v74, s[24:27], s88 offen
    buffer_load_ushort v162, v74, s[24:27], s88 offen offset:64
    s_mov_b64 exec, 1
    s_mov_b64 exec, -1
    v_lshlrev_b32 v76, 2, v0
    v_mov_b32 v77, 0
    v_cmp_gt_u32 vcc, 272, v0
    s_and_b64 exec, exec, vcc
    ds_write_b32 v76, v77
    s_mov_b64 exec, -1
    s_mov_b32 s4, s50
    s_and_b32 s5, s51, 0xffff
    s_mov_b32 s6, 19922944
    s_mov_b32 s7, 0x00020000
    s_sub_u32 s8, s50, 1246822400
    s_subb_u32 s9, s51, 0
    s_and_b32 s9, s9, 0xffff
    s_mov_b32 s10, 1264756736
    s_mov_b32 s11, 0x00020000
    s_mul_i32 s88, s62, 98
    s_sub_u32 s89, 25000, s88
    s_min_u32 s89, s89, 98
    s_lshl_b32 s90, s88, 7
    s_add_u32 s12, s48, s90
    s_addc_u32 s13, s49, 0
    s_and_b32 s13, s13, 0xffff
    s_lshl_b32 s14, s89, 7
    s_mov_b32 s15, 0x00020000
    s_mov_b32 s78, 1.0
    s_mov_b32 s79, 1.0
    s_mov_b32 s80, 16
    s_mov_b32 s81, 16
    s_mov_b32 s82, 3216550459
    s_mov_b32 s83, 3216550459
    s_mov_b32 s75, 0
    s_lshl_b32 s74, s63, 6
    s_add_u32 s74, s74, 1600
    s_mov_b32 s92, 42800
    s_mov_b32 s93, 4294967198
    v_mov_b32 v46, 1
    v_mov_b32 v161, 0
    v_mov_b32 v163, 0
    v_mov_b32 v164, 0x3f80
    v_mov_b32 v165, 0
    v_lshrrev_b32 v68, 5, v1
    v_bfe_u32 v69, v1, 2, 2
    v_lshl_add_u32 v70, v68, 5, v69
    s_mov_b32 s88, 76032
    v_lshl_add_u32 v70, v70, 8, s88
    v_bfe_u32 v71, v1, 4, 1
    v_lshl_add_u32 v70, v71, 5, v70
    v_and_b32 v71, 3, v1
    v_lshl_add_u32 v70, v71, 3, v70
    s_and_b32 s88, s63, 1
    s_lshl_b32 s88, s88, 1
    v_xor_b32 v71, s88, v69
    v_lshl_add_u32 v166, v71, 6, v70
    v_xor_b32 v71, 1, v71
    v_lshl_add_u32 v167, v71, 6, v70
    s_lshr_b32 s88, s63, 1
    s_lshl_b32 s88, s88, 5
    v_and_b32 v78, 31, v1
    v_add_u32 v78, s88, v78
    v_bfe_u32 v71, v1, 1, 3
    v_lshlrev_b32 v72, 2, v68
    v_xor_b32 v71, v71, v72
    v_lshlrev_b32 v71, 4, v71
    v_lshl_add_u32 v79, v78, 7, v71
    v_add_u32 v79, 47104, v79
    s_waitcnt vmcnt(9)
    v_mul_u32_u24 v68, s92, v48
    v_lshrrev_b32 v68, 22, v68
    v_mad_i32_i24 v48, v68, s93, v48
    v_lshlrev_b32 v68, 2, v68
    ds_add_rtn_u32 v73, v68, v46 offset:1600
    v_mul_u32_u24 v69, s92, v49
    v_lshrrev_b32 v69, 22, v69
    v_mad_i32_i24 v49, v69, s93, v49
    v_lshlrev_b32 v69, 2, v69
    ds_add_rtn_u32 v74, v69, v46 offset:1600
    v_mul_u32_u24 v70, s92, v50
    v_lshrrev_b32 v70, 22, v70
    v_mad_i32_i24 v50, v70, s93, v50
    v_lshlrev_b32 v70, 2, v70
    ds_add_rtn_u32 v75, v70, v46 offset:1600
    v_mul_u32_u24 v71, s92, v51
    v_lshrrev_b32 v71, 22, v71
    v_mad_i32_i24 v51, v71, s93, v51
    v_lshlrev_b32 v71, 2, v71
    ds_add_rtn_u32 v76, v71, v46 offset:1600
    s_cmp_lg_u32 s63, 9
    s_cbranch_scc1 L_noex1
    s_mov_b32 exec_lo, 4294967295
    s_mov_b32 exec_hi, 2097151
    v_mul_u32_u24 v72, s92, v64
    v_lshrrev_b32 v72, 22, v72
    v_mad_i32_i24 v64, v72, s93, v64
    v_lshlrev_b32 v72, 2, v72
    ds_add_rtn_u32 v77, v72, v46 offset:1600
    s_mov_b64 exec, -1
L_noex1:
    s_waitcnt vmcnt(6) lgkmcnt(0)
    s_barrier
    s_cmp_lt_u32 s63, 8
    s_cbranch_scc1 L_ptask
    s_cmp_lg_u32 s63, 8
    s_cbranch_scc1 L_noscan
    ds_read_b128 v[80:83], v45 offset:1600
    s_waitcnt lgkmcnt(0)
    v_add_u32 v84, v80, v81
    v_add_u32 v85, v84, v82
    v_add_u32 v86, v85, v83
    v_mov_b32 v87, v86
    s_nop 1
    v_add_u32_dpp v87, v87, v87 row_shr:1 row_mask:0xf bank_mask:0xf bound_ctrl:0
    s_nop 1
    v_add_u32_dpp v87, v87, v87 row_shr:2 row_mask:0xf bank_mask:0xf bound_ctrl:0
    s_nop 1
    v_add_u32_dpp v87, v87, v87 row_shr:4 row_mask:0xf bank_mask:0xf bound_ctrl:0
    s_nop 1
    v_add_u32_dpp v87, v87, v87 row_shr:8 row_mask:0xf bank_mask:0xf bound_ctrl:0
    s_nop 1
    v_add_u32_dpp v87, v87, v87 row_bcast:15 row_mask:0xa bank_mask:0xf
    s_nop 1
    v_add_u32_dpp v87, v87, v87 row_bcast:31 row_mask:0xc bank_mask:0xf
    s_nop 1
    v_sub_u32 v88, v87, v86
    v_add_u32 v89, v88, v80
    v_add_u32 v90, v88, v84
    v_add_u32 v91, v88, v85
    v_mov_b32 v96, 9472
    v_mad_u32_u24 v92, v88, 12, v96
    v_mad_u32_u24 v93, v89, 12, v96
    v_mad_u32_u24 v94, v90, 12, v96
    v_mad_u32_u24 v95, v91, 12, v96
    ds_write_b128 v45, v[92:95] offset:1600
    v_lshl_or_b32 v16, v80, 12, v88
    v_lshl_or_b32 v18, v81, 12, v89
    v_lshl_or_b32 v20, v82, 12, v90
    v_lshl_or_b32 v22, v83, 12, v91
    s_branch L_p_done
L_noscan:
    s_cmp_eq_u32 s63, 11
    s_cbranch_scc1 L_w2ld
    s_cmp_lg_u32 s63, 10
    s_cbranch_scc1 L_p_done
    v_lshlrev_b32 v80, 16, v12
    v_and_b32 v81, 0xffff0000, v12
    v_lshlrev_b32 v82, 16, v13
    v_and_b32 v83, 0xffff0000, v13
    v_lshlrev_b32 v84, 16, v14
    v_and_b32 v85, 0xffff0000, v14
    v_lshlrev_b32 v86, 16, v15
    v_and_b32 v87, 0xffff0000, v15
    v_pk_mul_f32 v[80:81], v[80:81], s[82:83]
    v_pk_mul_f32 v[82:83], v[82:83], s[82:83]
    v_pk_mul_f32 v[84:85], v[84:85], s[82:83]
    v_pk_mul_f32 v[86:87], v[86:87], s[82:83]
    v_cvt_pk_bf16_f32 v12, v80, v81
    v_cvt_pk_bf16_f32 v13, v82, v83
    v_cvt_pk_bf16_f32 v14, v84, v85
    v_cvt_pk_bf16_f32 v15, v86, v87
    v_lshrrev_b32 v88, 4, v1
    v_mul_u32_u24 v88, 264, v88
    v_and_b32 v89, 15, v1
    v_lshl_add_u32 v88, v89, 4, v88
    v_add_u32 v88, 159984, v88
    ds_write2_b64 v88, v[12:13], v[14:15] offset0:0 offset1:1
    v_mov_b32 v90, 0
    v_mov_b32 v91, 0
    s_mov_b32 exec_lo, 255
    s_mov_b32 exec_hi, 0
    v_mov_b32 v90, 16256
    s_mov_b32 exec_lo, 16711680
    s_mov_b32 exec_hi, 0
    v_mov_b32 v90, 1065353216
    s_mov_b32 exec_lo, 0
    s_mov_b32 exec_hi, 255
    v_mov_b32 v91, 16256
    s_mov_b32 exec_lo, 0
    s_mov_b32 exec_hi, 16711680
    v_mov_b32 v91, 1065353216
    s_mov_b64 exec, -1
    v_lshlrev_b32 v88, 3, v1
    ds_write_b64 v88, v[90:91] offset:1088
    s_branch L_p_done
L_ptask:
    v_xor_b32 v41, 16, v79
    v_xor_b32 v42, 32, v79
    v_xor_b32 v43, 48, v79
    ds_read_b128 v[112:115], v79
    ds_read_b64_tr_b16 v[80:81], v166 offset:0
    ds_read_b64_tr_b16 v[82:83], v166 offset:1024
    ds_read_b64_tr_b16 v[96:97], v167 offset:0
    ds_read_b64_tr_b16 v[98:99], v167 offset:1024
    ds_read_b128 v[116:119], v41
    ds_read_b64_tr_b16 v[84:85], v166 offset:2048
    ds_read_b64_tr_b16 v[86:87], v166 offset:3072
    ds_read_b64_tr_b16 v[100:101], v167 offset:2048
    ds_read_b64_tr_b16 v[102:103], v167 offset:3072
    ds_read_b128 v[120:123], v42
    ds_read_b64_tr_b16 v[88:89], v166 offset:4096
    ds_read_b64_tr_b16 v[90:91], v166 offset:5120
    ds_read_b64_tr_b16 v[104:105], v167 offset:4096
    ds_read_b64_tr_b16 v[106:107], v167 offset:5120
    ds_read_b128 v[124:127], v43
    ds_read_b64_tr_b16 v[92:93], v166 offset:6144
    ds_read_b64_tr_b16 v[94:95], v166 offset:7168
    ds_read_b64_tr_b16 v[108:109], v167 offset:6144
    ds_read_b64_tr_b16 v[110:111], v167 offset:7168
    v_cmp_gt_u32 vcc, 98, v78
    s_mov_b64 s[84:85], vcc
    v_lshrrev_b32 v41, 5, v1
    s_and_b32 s89, s63, 1
    s_lshl_b32 s89, s89, 3
    v_add_u32 v41, s89, v41
    v_and_b32 v42, 15, v78
    v_xor_b32 v41, v41, v42
    v_lshlrev_b32 v41, 4, v41
    v_lshl_add_u32 v41, v78, 8, v41
    v_add_u32 v41, 108800, v41
    v_xor_b32 v42, 32, v41
    v_xor_b32 v43, 64, v41
    v_xor_b32 v44, 0x60, v41
    s_waitcnt lgkmcnt(15)
    v_mfma_f32_32x32x16_bf16 v[128:143], v[80:83], v[112:115], 0
    v_mfma_f32_32x32x16_bf16 v[144:159], v[96:99], v[112:115], 0
    s_waitcnt lgkmcnt(10)
    v_mfma_f32_32x32x16_bf16 v[128:143], v[84:87], v[116:119], v[128:143]
    v_mfma_f32_32x32x16_bf16 v[144:159], v[100:103], v[116:119], v[144:159]
    s_waitcnt lgkmcnt(5)
    v_mfma_f32_32x32x16_bf16 v[128:143], v[88:91], v[120:123], v[128:143]
    v_mfma_f32_32x32x16_bf16 v[144:159], v[104:107], v[120:123], v[144:159]
    s_waitcnt lgkmcnt(0)
    v_mfma_f32_32x32x16_bf16 v[128:143], v[92:95], v[124:127], v[128:143]
    v_mfma_f32_32x32x16_bf16 v[144:159], v[108:111], v[124:127], v[144:159]
    s_mov_b32 s88, 0x07060302
    s_nop 10
    v_pk_mul_f32 v[128:129], v[128:129], s[82:83]
    v_pk_mul_f32 v[130:131], v[130:131], s[82:83]
    v_pk_mul_f32 v[132:133], v[132:133], s[82:83]
    v_pk_mul_f32 v[134:135], v[134:135], s[82:83]
    v_pk_mul_f32 v[136:137], v[136:137], s[82:83]
    v_pk_mul_f32 v[138:139], v[138:139], s[82:83]
    v_pk_mul_f32 v[140:141], v[140:141], s[82:83]
    v_pk_mul_f32 v[142:143], v[142:143], s[82:83]
    v_pk_mul_f32 v[144:145], v[144:145], s[82:83]
    v_pk_mul_f32 v[146:147], v[146:147], s[82:83]
    v_pk_mul_f32 v[148:149], v[148:149], s[82:83]
    v_pk_mul_f32 v[150:151], v[150:151], s[82:83]
    v_pk_mul_f32 v[152:153], v[152:153], s[82:83]
    v_pk_mul_f32 v[154:155], v[154:155], s[82:83]
    v_pk_mul_f32 v[156:157], v[156:157], s[82:83]
    v_pk_mul_f32 v[158:159], v[158:159], s[82:83]
    s_mov_b64 exec, s[84:85]
    v_add_u32 v128, 0x4000, v128
    v_add_u32 v129, 0x4000, v129
    v_add_u32 v130, 0x4000, v130
    v_add_u32 v131, 0x4000, v131
    v_perm_b32 v128, v144, v128, s88
    v_perm_b32 v129, v145, v129, s88
    v_perm_b32 v130, v146, v130, s88
    v_perm_b32 v131, v147, v131, s88
    ds_write_b128 v41, v[128:131]
    v_add_u32 v132, 0x4000, v132
    v_add_u32 v133, 0x4000, v133
    v_add_u32 v134, 0x4000, v134
    v_add_u32 v135, 0x4000, v135
    v_perm_b32 v132, v148, v132, s88
    v_perm_b32 v133, v149, v133, s88
    v_perm_b32 v134, v150, v134, s88
    v_perm_b32 v135, v151, v135, s88
    ds_write_b128 v42, v[132:135]
    v_add_u32 v136, 0x4000, v136
    v_add_u32 v137, 0x4000, v137
    v_add_u32 v138, 0x4000, v138
    v_add_u32 v139, 0x4000, v139
    v_perm_b32 v136, v152, v136, s88
    v_perm_b32 v137, v153, v137, s88
    v_perm_b32 v138, v154, v138, s88
    v_perm_b32 v139, v155, v139, s88
    ds_write_b128 v43, v[136:139]
    v_add_u32 v140, 0x4000, v140
    v_add_u32 v141, 0x4000, v141
    v_add_u32 v142, 0x4000, v142
    v_add_u32 v143, 0x4000, v143
    v_perm_b32 v140, v156, v140, s88
    v_perm_b32 v141, v157, v141, s88
    v_perm_b32 v142, v158, v142, s88
    v_perm_b32 v143, v159, v143, s88
    ds_write_b128 v44, v[140:143]
    s_mov_b64 exec, -1
L_p_done:
    v_lshrrev_b32 v80, 4, v0
    v_xor_b32 v81, v80, v0
    v_and_b32 v81, 15, v81
    v_lshlrev_b32 v81, 4, v81
    v_lshl_add_u32 v81, v80, 8, v81
    v_add_u32 v81, 108800, v81
    s_mul_i32 s88, s62, 25088
    s_add_u32 s88, s88, 11534336
    s_add_u32 s16, s50, s88
    s_addc_u32 s17, s51, 0
    s_and_b32 s17, s17, 0xffff
    s_mov_b32 s18, 25088
    s_mov_b32 s19, 0x00020000
    s_mul_i32 s88, s2, 37632
    s_add_u32 s88, s88, 1048576
    s_add_u32 s20, s50, s88
    s_addc_u32 s21, s51, 0
    s_and_b32 s21, s21, 0xffff
    s_mov_b32 s22, 37504
    s_mov_b32 s23, 0x00020000
    s_mov_b32 s89, 12288
    s_mov_b32 s90, 24576
    s_mov_b32 s91, 36864
    s_waitcnt lgkmcnt(0)
    s_barrier
    ds_read_b128 v[84:87], v81
    ds_read_b128 v[88:91], v81 offset:12288
    ds_read_b128 v[92:95], v81 offset:24576
    ds_read_b32 v68, v68 offset:1600
    ds_read_b32 v69, v69 offset:1600
    ds_read_b32 v70, v70 offset:1600
    ds_read_b32 v71, v71 offset:1600
    ds_read_b32 v72, v72 offset:1600
    s_waitcnt lgkmcnt(7)
    buffer_store_dwordx4 v[84:87], v40, s[16:19], 0 offen sc1
    s_waitcnt lgkmcnt(6)
    buffer_store_dwordx4 v[88:91], v40, s[16:19], s89 offen sc1
    s_waitcnt lgkmcnt(5)
    buffer_store_dwordx4 v[92:95], v40, s[16:19], s90 offen sc1
    s_waitcnt vmcnt(7)
    s_movk_i32 s92, 0x804
    s_mov_b32 s93, 66585596
    v_lshlrev_b32 v80, 11, v52
    v_lshlrev_b32 v48, 12, v48
    v_lshlrev_b32_sdwa v80, 2, v52 dst_sel:WORD_0 dst_unused:UNUSED_PRESERVE src0_sel:DWORD src1_sel:BYTE_0
    v_lshlrev_b32 v81, 11, v53
    v_lshlrev_b32 v49, 12, v49
    v_lshlrev_b32_sdwa v81, 2, v53 dst_sel:WORD_0 dst_unused:UNUSED_PRESERVE src0_sel:DWORD src1_sel:BYTE_0
    v_lshlrev_b32 v82, 11, v54
    v_lshlrev_b32 v50, 12, v50
    v_lshlrev_b32_sdwa v82, 2, v54 dst_sel:WORD_0 dst_unused:UNUSED_PRESERVE src0_sel:DWORD src1_sel:BYTE_0
    v_lshlrev_b32 v83, 11, v55
    v_lshlrev_b32 v51, 12, v51
    v_lshlrev_b32_sdwa v83, 2, v55 dst_sel:WORD_0 dst_unused:UNUSED_PRESERVE src0_sel:DWORD src1_sel:BYTE_0
    v_and_or_b32 v48, v80, s93, v48
    v_and_or_b32 v49, v81, s93, v49
    v_and_or_b32 v50, v82, s93, v50
    v_and_or_b32 v51, v83, s93, v51
    s_waitcnt lgkmcnt(0)
    v_mad_u32_u24 v68, v73, 12, v68
    v_mad_u32_u24 v69, v74, 12, v69
    v_mad_u32_u24 v70, v75, 12, v70
    v_mad_u32_u24 v71, v76, 12, v71
    v_mad_u32_u24 v72, v77, 12, v72
    ds_write_b32 v68, v48 offset:8
    ds_write_b32 v69, v49 offset:8
    ds_write_b32 v70, v50 offset:8
    ds_write_b32 v71, v51 offset:8
    s_cmp_lg_u32 s63, 9
    s_cbranch_scc1 L_noex2
    s_mov_b32 exec_lo, 4294967295
    s_mov_b32 exec_hi, 2097151
    v_lshlrev_b32 v80, 11, v65
    v_lshlrev_b32 v64, 12, v64
    v_lshlrev_b32_sdwa v80, 2, v65 dst_sel:WORD_0 dst_unused:UNUSED_PRESERVE src0_sel:DWORD src1_sel:BYTE_0
    s_nop 0
    v_and_or_b32 v64, v80, s93, v64
    ds_write2_b32 v72, v66, v67 offset0:0 offset1:1
    ds_write_b32 v72, v64 offset:8
    s_mov_b64 exec, -1
L_noex2:
    s_waitcnt vmcnt(6)
    ds_write2_b32 v68, v56, v57 offset0:0 offset1:1
    ds_write2_b32 v69, v58, v59 offset0:0 offset1:1
    s_waitcnt vmcnt(5)
    ds_write2_b32 v70, v60, v61 offset0:0 offset1:1
    ds_write2_b32 v71, v62, v63 offset0:0 offset1:1
    s_waitcnt lgkmcnt(0)
    s_barrier
    ds_read_b128 v[48:51], v40 offset:9472
    ds_read_b128 v[52:55], v40 offset:21760
    ds_read_b128 v[56:59], v40 offset:34048
    ds_read_b128 v[60:63], v40 offset:46336
    s_waitcnt lgkmcnt(3)
    buffer_store_dwordx4 v[48:51], v40, s[20:23], 0 offen sc1
    s_waitcnt lgkmcnt(2)
    buffer_store_dwordx4 v[52:55], v40, s[20:23], s89 offen sc1
    s_waitcnt lgkmcnt(1)
    buffer_store_dwordx4 v[56:59], v40, s[20:23], s90 offen sc1
    s_waitcnt lgkmcnt(0)
    s_cmp_lg_u32 s63, 0
    s_cbranch_scc1 L_no4
    buffer_store_dwordx4 v[60:63], v40, s[20:23], s91 offen sc1
L_no4:
    s_cmp_ge_u32 s63, 8
    s_cbranch_scc1 L_nop2
    ds_read_b64_tr_b16 v[80:81], v166 offset:16384
    ds_read_b64_tr_b16 v[82:83], v166 offset:17408
    ds_read_b64_tr_b16 v[96:97], v167 offset:16384
    ds_read_b64_tr_b16 v[98:99], v167 offset:17408
    ds_read_b64_tr_b16 v[84:85], v166 offset:18432
    ds_read_b64_tr_b16 v[86:87], v166 offset:19456
    ds_read_b64_tr_b16 v[100:101], v167 offset:18432
    ds_read_b64_tr_b16 v[102:103], v167 offset:19456
    ds_read_b64_tr_b16 v[88:89], v166 offset:20480
    ds_read_b64_tr_b16 v[90:91], v166 offset:21504
    ds_read_b64_tr_b16 v[104:105], v167 offset:20480
    ds_read_b64_tr_b16 v[106:107], v167 offset:21504
    ds_read_b64_tr_b16 v[92:93], v166 offset:22528
    ds_read_b64_tr_b16 v[94:95], v166 offset:23552
    ds_read_b64_tr_b16 v[108:109], v167 offset:22528
    ds_read_b64_tr_b16 v[110:111], v167 offset:23552
    s_waitcnt vmcnt(6)
    v_mfma_f32_32x32x8_bf16 v[128:143], v[160:161], v[164:165], 0
    v_mfma_f32_32x32x8_bf16 v[144:159], v[162:163], v[164:165], 0
    v_lshrrev_b32 v41, 5, v1
    s_and_b32 s88, s63, 1
    s_lshl_b32 s88, s88, 7
    s_add_u32 s88, s88, 134112
    v_lshl_add_u32 v41, v41, 3, s88
    v_mul_u32_u24 v42, 264, v78
    v_add_u32 v41, v41, v42
    s_waitcnt lgkmcnt(12)
    v_mfma_f32_32x32x16_bf16 v[128:143], v[80:83], v[112:115], v[128:143]
    v_mfma_f32_32x32x16_bf16 v[144:159], v[96:99], v[112:115], v[144:159]
    s_waitcnt lgkmcnt(8)
    v_mfma_f32_32x32x16_bf16 v[128:143], v[84:87], v[116:119], v[128:143]
    v_mfma_f32_32x32x16_bf16 v[144:159], v[100:103], v[116:119], v[144:159]
    s_waitcnt lgkmcnt(4)
    v_mfma_f32_32x32x16_bf16 v[128:143], v[88:91], v[120:123], v[128:143]
    v_mfma_f32_32x32x16_bf16 v[144:159], v[104:107], v[120:123], v[144:159]
    s_waitcnt lgkmcnt(0)
    v_mfma_f32_32x32x16_bf16 v[128:143], v[92:95], v[124:127], v[128:143]
    v_mfma_f32_32x32x16_bf16 v[144:159], v[108:111], v[124:127], v[144:159]
    s_nop 11
    v_pk_mul_f32 v[128:129], v[128:129], s[82:83]
    v_pk_mul_f32 v[130:131], v[130:131], s[82:83]
    v_pk_mul_f32 v[132:133], v[132:133], s[82:83]
    v_pk_mul_f32 v[134:135], v[134:135], s[82:83]
    v_pk_mul_f32 v[136:137], v[136:137], s[82:83]
    v_pk_mul_f32 v[138:139], v[138:139], s[82:83]
    v_pk_mul_f32 v[140:141], v[140:141], s[82:83]
    v_pk_mul_f32 v[142:143], v[142:143], s[82:83]
    v_pk_mul_f32 v[144:145], v[144:145], s[82:83]
    v_pk_mul_f32 v[146:147], v[146:147], s[82:83]
    v_pk_mul_f32 v[148:149], v[148:149], s[82:83]
    v_pk_mul_f32 v[150:151], v[150:151], s[82:83]
    v_pk_mul_f32 v[152:153], v[152:153], s[82:83]
    v_pk_mul_f32 v[154:155], v[154:155], s[82:83]
    v_pk_mul_f32 v[156:157], v[156:157], s[82:83]
    v_pk_mul_f32 v[158:159], v[158:159], s[82:83]
    v_cvt_pk_bf16_f32 v128, v128, v129
    v_cvt_pk_bf16_f32 v129, v130, v131
    v_cvt_pk_bf16_f32 v130, v132, v133
    v_cvt_pk_bf16_f32 v131, v134, v135
    v_cvt_pk_bf16_f32 v132, v136, v137
    v_cvt_pk_bf16_f32 v133, v138, v139
    v_cvt_pk_bf16_f32 v134, v140, v141
    v_cvt_pk_bf16_f32 v135, v142, v143
    v_cvt_pk_bf16_f32 v136, v144, v145
    v_cvt_pk_bf16_f32 v137, v146, v147
    v_cvt_pk_bf16_f32 v138, v148, v149
    v_cvt_pk_bf16_f32 v139, v150, v151
    v_cvt_pk_bf16_f32 v140, v152, v153
    v_cvt_pk_bf16_f32 v141, v154, v155
    v_cvt_pk_bf16_f32 v142, v156, v157
    v_cvt_pk_bf16_f32 v143, v158, v159
    s_mov_b64 exec, s[84:85]
    ds_write_b64 v41, v[128:129] offset:0
    ds_write_b64 v41, v[130:131] offset:16
    ds_write_b64 v41, v[132:133] offset:32
    ds_write_b64 v41, v[134:135] offset:48
    ds_write_b64 v41, v[136:137] offset:64
    ds_write_b64 v41, v[138:139] offset:80
    ds_write_b64 v41, v[140:141] offset:96
    ds_write_b64 v41, v[142:143] offset:112
    s_mov_b64 exec, -1
    s_branch L_p2_done
L_nop2:
    s_cmp_lg_u32 s63, 11
    s_cbranch_scc1 L_p2_done
    s_cmp_gt_u32 s2, 16
    s_cbranch_scc1 L_p2_done
    s_lshl_b32 s88, s2, 10
    s_add_u32 s88, s88, 622592
    s_waitcnt vmcnt(6)
    s_cmp_lt_u32 s2, 16
    s_cbranch_scc1 L_w2st
    v_lshlrev_b32 v32, 16, v32
    v_mul_f32 v32, s82, v32
    v_lshlrev_b32 v33, 2, v1
    buffer_store_dword v32, v33, s[4:7], s88 offen sc1
    s_branch L_p2_done
L_w2st:
    v_lshl_or_b32 v32, v33, 16, v32
    v_lshl_or_b32 v33, v35, 16, v34
    v_lshl_or_b32 v34, v37, 16, v36
    v_lshl_or_b32 v35, v39, 16, v38
    buffer_store_dwordx4 v[32:35], v45, s[4:7], s88 offen sc1
L_p2_done:
    v_and_b32 v72, 31, v1
    v_lshlrev_b32 v72, 2, v72
    v_add_u32 v8, 76032, v72
    v_add_u32 v9, 76032, v72
    v_cvt_f32_u32 v72, v72
    v_mov_b32 v30, 0x78005c00
    v_cvt_f16_f32 v31, v72
    v_and_b32 v31, 0xffff, v31
    s_mov_b32 exec_lo, 0
    v_mov_b32 v30, 0
    v_mov_b32 v31, 0
    s_mov_b64 exec, -1
    v_mov_b32 v39, 0x3c00
    v_bfe_u32 v73, v1, 4, 1
    v_lshlrev_b32 v73, 5, v73
    v_and_b32 v74, 3, v1
    v_lshl_add_u32 v73, v74, 3, v73
    v_add_u32 v44, 134112, v73
    v_bfe_u32 v75, v1, 2, 2
    v_add_u32 v76, 98, v75
    v_mul_u32_u24 v76, 264, v76
    v_add_u32 v10, v76, v44
    v_bfe_u32 v72, v1, 3, 2
    v_bfe_u32 v73, v1, 1, 1
    v_lshl_add_u32 v72, v72, 1, v73
    v_lshlrev_b32 v6, 3, v72
    v_lshlrev_b32 v7, 2, v72
    v_bfe_u32 v73, v1, 2, 1
    v_and_b32 v74, 1, v1
    v_lshl_add_u32 v73, v73, 1, v74
    v_lshlrev_b32 v73, 7, v73
    s_mov_b32 exec_lo, 0
    v_add_u32 v6, v6, v73
    v_add_u32 v6, 1088, v6
    s_mov_b64 exec, -1
    v_lshrrev_b32 v72, 5, v1
    v_bfe_u32 v74, v1, 2, 1
    v_and_b32 v75, 1, v1
    v_lshlrev_b32 v72, 1, v72
    v_lshl_add_u32 v74, v74, 1, v75
    v_add_u32 v73, 1, v72
    v_bfe_u32 v75, v1, 2, 2
    v_lshl_add_u32 v2, v72, 4, s74
    v_lshl_add_u32 v4, v74, 4, s74
    v_lshl_add_u32 v5, v75, 4, s74
    v_add_u32 v2, 12, v2
    v_lshl_add_u32 v4, v72, 1, v4
    v_add_u32 v5, 14, v5
    v_add_u32 v3, 16, v2
    s_add_u32 s72, s72, 1
    s_mul_i32 s73, s72, 0x9e3779b1
    s_and_b32 s73, s73, 0xff000000
    v_or_b32 v16, s73, v16
    v_or_b32 v18, s73, v18
    v_or_b32 v20, s73, v20
    v_or_b32 v22, s73, v22
    v_mov_b32 v17, s72
    v_mov_b32 v19, s72
    v_mov_b32 v21, s72
    v_mov_b32 v23, s72
    s_waitcnt vmcnt(0) lgkmcnt(0)
    s_barrier
    s_cmp_lg_u32 s63, 8
    s_cbranch_scc1 L_nopub
    v_lshlrev_b32 v72, 4, v1
    s_lshl_b32 s88, s2, 11
    s_add_u32 s88, s88, 65536
    buffer_store_dwordx4 v[16:19], v72, s[4:7], s88 offen sc0 sc1
    buffer_store_dwordx4 v[20:23], v72, s[4:7], s88 offen offset:1024 sc0 sc1
L_nopub:
    s_mov_b32 s88, 1561
    v_mul_u32_u24 v69, s88, v0
    v_lshrrev_b32 v69, 16, v69
    v_mul_u32_u24 v69, 42, v69
    v_sub_u32 v69, v0, v69
    v_cmp_gt_u32 vcc, 14, v69
    v_mov_b32 v70, 1609587712
    v_lshlrev_b32 v71, 4, v0
    v_cndmask_b32 v64, 0, v70, vcc
    v_add_u32 v68, 9472, v71
    v_mov_b32 v65, v64
    v_mov_b32 v66, v64
    v_mov_b32 v67, v64
    v_cmp_gt_u32 vcc, 756, v0
    s_and_b64 exec, exec, vcc
    ds_write_b128 v68, v[64:67] offset:0
    ds_write_b128 v68, v[64:67] offset:12096
    ds_write_b128 v68, v[64:67] offset:24192
    ds_write_b128 v68, v[64:67] offset:36288
    ds_write_b128 v68, v[64:67] offset:48384
    v_cmp_gt_u32 vcc, 378, v0
    s_and_b64 exec, exec, vcc
    ds_write_b128 v68, v[64:67] offset:60480
    s_mov_b64 exec, -1
    v_mov_b32 v72, 75520
    v_mov_b32 v73, 75936
    v_mov_b32 v74, 64
    v_mov_b32 v75, 1695599136
    v_cmp_gt_u32 vcc, 488, v0
    s_and_b64 exec, exec, vcc
    ds_write_b128 v71, v[72:75] offset:1600
    s_mov_b64 exec, -1
    v_lshrrev_b32 v141, 3, v1
    v_lshlrev_b32 v136, 11, v141
    v_and_b32 v138, 7, v1
    v_mul_u32_u24 v139, 12, v138
    s_mov_b32 s88, 37632
    v_mad_u32_u24 v139, v141, s88, v139
    s_lshl_b32 s65, s63, 14
    s_lshr_b32 s89, s62, 2
    s_lshl_b32 s89, s89, 4
    s_add_u32 s65, s65, s89
    s_and_b32 s89, s62, 1
    s_lshl_b32 s89, s89, 3
    s_add_u32 s65, s65, s89
    s_and_b32 s89, s62, 2
    s_lshl_b32 s89, s89, 9
    s_add_u32 s65, s65, s89
    s_add_u32 s65, s65, 65536
    s_add_u32 s66, s65, 196608
    s_add_u32 s67, s65, 393216
    s_mul_i32 s68, s63, 301056
    s_add_u32 s68, s68, 1048576
    s_mov_b64 s[16:17], -1
    s_mov_b64 s[18:19], -1
    s_cmp_lt_u32 s63, 8
    s_cselect_b64 s[20:21], -1, 0
    v_mov_b32 v128, s73
    v_mov_b32 v129, s72
    s_mov_b32 s69, 0
    v_mov_b32 v140, 9472
    s_movk_i32 s92, 168
    s_mov_b32 s93, 66585596
    v_mov_b32 v137, 1543527424
    v_mov_b32 v143, 0
    s_waitcnt lgkmcnt(0)
    s_barrier
    s_branch L_poll1
L_poll:
    s_sleep 2
L_poll1:
    s_mov_b64 exec, s[16:17]
    s_cbranch_execz L_pk0
    buffer_load_dwordx2 v[124:125], v136, s[4:7], s65 offen sc1
L_pk0:
    s_mov_b64 exec, s[18:19]
    s_cbranch_execz L_pk1
    buffer_load_dwordx2 v[126:127], v136, s[4:7], s66 offen sc1
L_pk1:
    s_mov_b64 exec, s[20:21]
    s_cbranch_execz L_pk2
    buffer_load_dwordx2 v[128:129], v136, s[4:7], s67 offen sc1
L_pk2:
    s_mov_b64 exec, -1
    s_add_u32 s69, s69, 1
    s_cmp_gt_u32 s69, 0x40000
    s_cbranch_scc1 L_exit
L_poll2:
    s_waitcnt vmcnt(0)
    v_xor_b32 v141, s73, v124
    v_xor_b32 v142, s72, v125
    v_lshrrev_b32 v141, 24, v141
    v_or_b32 v141, v141, v142
    v_cmp_ne_u32 s[16:17], 0, v141
    v_xor_b32 v141, s73, v126
    v_xor_b32 v142, s72, v127
    v_lshrrev_b32 v141, 24, v141
    v_or_b32 v141, v141, v142
    v_cmp_ne_u32 s[18:19], 0, v141
    v_xor_b32 v141, s73, v128
    v_xor_b32 v142, s72, v129
    v_lshrrev_b32 v141, 24, v141
    v_or_b32 v141, v141, v142
    v_cmp_ne_u32 s[20:21], 0, v141
    s_or_b64 s[84:85], s[16:17], s[18:19]
    s_or_b64 s[84:85], s[84:85], s[20:21]
    s_cbranch_scc1 L_poll
    v_and_b32 v130, 0xfff, v124
    v_mad_u32_u24 v130, v130, 12, v139
    v_bfe_u32 v133, v124, 12, 12
    v_sub_u32 v133, v133, v138
    v_and_b32 v131, 0xfff, v126
    v_mad_u32_u24 v131, v131, 12, v139
    v_add_u32 v131, 3612672, v131
    v_bfe_u32 v134, v126, 12, 12
    v_sub_u32 v134, v134, v138
    v_and_b32 v132, 0xfff, v128
    v_mad_u32_u24 v132, v132, 12, v139
    v_add_u32 v132, 7225344, v132
    v_bfe_u32 v135, v128, 12, 12
    v_sub_u32 v135, v135, v138
    v_cmp_lt_i32 s[32:33], 0, v133
    v_cmp_lt_i32 s[34:35], 8, v133
    v_cmp_lt_i32 s[36:37], 16, v133
    v_cmp_lt_i32 s[38:39], 24, v133
    v_cmp_lt_i32 s[40:41], 32, v133
    v_cmp_lt_i32 s[42:43], 0, v134
    v_cmp_lt_i32 s[44:45], 8, v134
    v_cmp_lt_i32 s[46:47], 16, v134
    v_cmp_lt_i32 s[48:49], 24, v134
    v_cmp_lt_i32 s[50:51], 32, v134
    v_cmp_lt_i32 s[52:53], 0, v135
    v_cmp_lt_i32 s[54:55], 8, v135
    v_cmp_lt_i32 s[56:57], 16, v135
    v_cmp_lt_i32 s[58:59], 24, v135
    v_cmp_lt_i32 s[60:61], 32, v135
    s_mov_b64 exec, s[32:33]
    buffer_load_dwordx3 v[48:50], v130, s[4:7], s68 offen offset:0 sc1
    s_mov_b64 exec, s[34:35]
    buffer_load_dwordx3 v[52:54], v130, s[4:7], s68 offen offset:96 sc1
    s_mov_b64 exec, s[36:37]
    s_cbranch_execz L_sg1
    buffer_load_dwordx3 v[56:58], v130, s[4:7], s68 offen offset:192 sc1
    s_mov_b64 exec, s[38:39]
    s_cbranch_execz L_sg1
    buffer_load_dwordx3 v[60:62], v130, s[4:7], s68 offen offset:288 sc1
    s_mov_b64 exec, s[40:41]
    s_cbranch_execz L_sg1
    buffer_load_dwordx3 v[64:66], v130, s[4:7], s68 offen offset:384 sc1
L_sg1:
    s_mov_b64 exec, s[42:43]
    buffer_load_dwordx3 v[68:70], v131, s[4:7], s68 offen offset:0 sc1
    s_mov_b64 exec, s[44:45]
    buffer_load_dwordx3 v[72:74], v131, s[4:7], s68 offen offset:96 sc1
    s_mov_b64 exec, s[46:47]
    s_cbranch_execz L_sg2
    buffer_load_dwordx3 v[76:78], v131, s[4:7], s68 offen offset:192 sc1
    s_mov_b64 exec, s[48:49]
    s_cbranch_execz L_sg2
    buffer_load_dwordx3 v[80:82], v131, s[4:7], s68 offen offset:288 sc1
    s_mov_b64 exec, s[50:51]
    s_cbranch_execz L_sg2
    buffer_load_dwordx3 v[84:86], v131, s[4:7], s68 offen offset:384 sc1
L_sg2:
    s_mov_b64 exec, s[52:53]
    s_cbranch_execz L_sg3
    buffer_load_dwordx3 v[88:90], v132, s[4:7], s68 offen offset:0 sc1
    s_mov_b64 exec, s[54:55]
    buffer_load_dwordx3 v[92:94], v132, s[4:7], s68 offen offset:96 sc1
    s_mov_b64 exec, s[56:57]
    s_cbranch_execz L_sg3
    buffer_load_dwordx3 v[96:98], v132, s[4:7], s68 offen offset:192 sc1
    s_mov_b64 exec, s[58:59]
    s_cbranch_execz L_sg3
    buffer_load_dwordx3 v[100:102], v132, s[4:7], s68 offen offset:288 sc1
    s_mov_b64 exec, s[60:61]
    s_cbranch_execz L_sg3
    buffer_load_dwordx3 v[104:106], v132, s[4:7], s68 offen offset:384 sc1
L_sg3:
    s_mov_b64 exec, -1
    v_max3_i32 v141, v133, v134, v135
    v_cmp_lt_i32 vcc, 40, v141
    s_cbranch_vccz L_nobig
    v_mov_b32 v141, 0
    ds_write_b32 v141, v46 offset:1040
L_nobig:
    v_mov_b32 v144, 0
    v_mov_b32 v145, 0
    v_mov_b32 v146, 0
    v_mov_b32 v147, 0
    v_lshlrev_b32 v148, 4, v0
    v_add_u32 v148, 76032, v148
    ds_write_b128 v148, v[144:147] offset:0
    ds_write_b128 v148, v[144:147] offset:12288
    ds_write_b128 v148, v[144:147] offset:24576
    ds_write_b128 v148, v[144:147] offset:36864
    v_cmp_gt_u32 vcc, 558, v0
    s_and_b64 exec, exec, vcc
    ds_write_b128 v148, v[144:147] offset:49152
    s_mov_b64 exec, -1
    v_mul_u32_u24 v32, 1344, v1
    v_add_u32 v32, 9472, v32
    v_add_u32 v33, 672, v32
    s_mov_b32 s88, 34604064
    v_mul_lo_u32 v34, v1, s88
    v_add_u32 v35, 17302032, v34
    s_cmp_ge_u32 s63, 6
    s_cselect_b64 s[28:29], -1, 0
    s_cselect_b32 s88, 6, 0
    s_sub_u32 s30, s63, s88
    v_cndmask_b32 v145, v32, v33, s[28:29]
    v_cndmask_b32 v147, v34, v35, s[28:29]
    s_lshl_b32 s88, s30, 5
    v_add_u32 v144, s88, v145
    s_add_u32 s88, s88, 224
    v_add_u32 v145, s88, v144
    v_lshlrev_b32 v152, 3, v1
    v_mov_b32 v153, 0
    v_mov_b32 v28, 0
    v_lshrrev_b32 v148, 5, v1
    v_bfe_u32 v150, v1, 2, 1
    v_and_b32 v151, 1, v1
    v_lshlrev_b32 v148, 1, v148
    v_lshl_add_u32 v150, v150, 1, v151
    v_add_u32 v149, 1, v148
    v_bfe_u32 v151, v1, 2, 2
    s_waitcnt vmcnt(0)
    s_mov_b64 exec, s[32:33]
    v_bfe_u32 v108, v50, 10, 9
    v_and_or_b32 v50, v50, s93, v137
    ds_add_rtn_u32 v51, v108, v46 offset:0
    v_mad_u32_u24 v108, v108, s92, v140
    s_mov_b64 exec, s[34:35]
    v_bfe_u32 v109, v54, 10, 9
    v_and_or_b32 v54, v54, s93, v137
    ds_add_rtn_u32 v55, v109, v46 offset:0
    v_mad_u32_u24 v109, v109, s92, v140
    s_mov_b64 exec, s[36:37]
    s_cbranch_execz L_sg4
    v_bfe_u32 v110, v58, 10, 9
    v_and_or_b32 v58, v58, s93, v137
    ds_add_rtn_u32 v59, v110, v46 offset:0
    v_mad_u32_u24 v110, v110, s92, v140
    s_mov_b64 exec, s[38:39]
    s_cbranch_execz L_sg4
    v_bfe_u32 v111, v62, 10, 9
    v_and_or_b32 v62, v62, s93, v137
    ds_add_rtn_u32 v63, v111, v46 offset:0
    v_mad_u32_u24 v111, v111, s92, v140
    s_mov_b64 exec, s[40:41]
    s_cbranch_execz L_sg4
    v_bfe_u32 v112, v66, 10, 9
    v_and_or_b32 v66, v66, s93, v137
    ds_add_rtn_u32 v67, v112, v46 offset:0
    v_mad_u32_u24 v112, v112, s92, v140
L_sg4:
    s_mov_b64 exec, s[42:43]
    v_bfe_u32 v113, v70, 10, 9
    v_and_or_b32 v70, v70, s93, v137
    ds_add_rtn_u32 v71, v113, v46 offset:0
    v_mad_u32_u24 v113, v113, s92, v140
    s_mov_b64 exec, s[44:45]
    v_bfe_u32 v114, v74, 10, 9
    v_and_or_b32 v74, v74, s93, v137
    ds_add_rtn_u32 v75, v114, v46 offset:0
    v_mad_u32_u24 v114, v114, s92, v140
    s_mov_b64 exec, s[46:47]
    s_cbranch_execz L_sg5
    v_bfe_u32 v115, v78, 10, 9
    v_and_or_b32 v78, v78, s93, v137
    ds_add_rtn_u32 v79, v115, v46 offset:0
    v_mad_u32_u24 v115, v115, s92, v140
    s_mov_b64 exec, s[48:49]
    s_cbranch_execz L_sg5
    v_bfe_u32 v116, v82, 10, 9
    v_and_or_b32 v82, v82, s93, v137
    ds_add_rtn_u32 v83, v116, v46 offset:0
    v_mad_u32_u24 v116, v116, s92, v140
    s_mov_b64 exec, s[50:51]
    s_cbranch_execz L_sg5
    v_bfe_u32 v117, v86, 10, 9
    v_and_or_b32 v86, v86, s93, v137
    ds_add_rtn_u32 v87, v117, v46 offset:0
    v_mad_u32_u24 v117, v117, s92, v140
L_sg5:
    s_mov_b64 exec, s[52:53]
    s_cbranch_execz L_sg6
    v_bfe_u32 v118, v90, 10, 9
    v_and_or_b32 v90, v90, s93, v137
    ds_add_rtn_u32 v91, v118, v46 offset:0
    v_mad_u32_u24 v118, v118, s92, v140
    s_mov_b64 exec, s[54:55]
    v_bfe_u32 v119, v94, 10, 9
    v_and_or_b32 v94, v94, s93, v137
    ds_add_rtn_u32 v95, v119, v46 offset:0
    v_mad_u32_u24 v119, v119, s92, v140
    s_mov_b64 exec, s[56:57]
    s_cbranch_execz L_sg6
    v_bfe_u32 v120, v98, 10, 9
    v_and_or_b32 v98, v98, s93, v137
    ds_add_rtn_u32 v99, v120, v46 offset:0
    v_mad_u32_u24 v120, v120, s92, v140
    s_mov_b64 exec, s[58:59]
    s_cbranch_execz L_sg6
    v_bfe_u32 v121, v102, 10, 9
    v_and_or_b32 v102, v102, s93, v137
    ds_add_rtn_u32 v103, v121, v46 offset:0
    v_mad_u32_u24 v121, v121, s92, v140
    s_mov_b64 exec, s[60:61]
    s_cbranch_execz L_sg6
    v_bfe_u32 v122, v106, 10, 9
    v_and_or_b32 v106, v106, s93, v137
    ds_add_rtn_u32 v107, v122, v46 offset:0
    v_mad_u32_u24 v122, v122, s92, v140
L_sg6:
    s_mov_b64 exec, -1
    s_waitcnt lgkmcnt(0)
    s_mov_b64 exec, s[32:33]
    v_cmp_le_u32 vcc, 56, v51
    v_lshl_add_u32 v141, v51, 2, v108
    v_lshl_add_u32 v108, v51, 3, v108
    s_cbranch_vccnz L_fx8
L_fr8:
    ds_write_b32 v141, v50
    ds_write_b64 v108, v[48:49] offset:224
    s_mov_b64 exec, s[34:35]
    v_cmp_le_u32 vcc, 56, v55
    v_lshl_add_u32 v141, v55, 2, v109
    v_lshl_add_u32 v109, v55, 3, v109
    s_cbranch_vccnz L_fx9
L_fr9:
    ds_write_b32 v141, v54
    ds_write_b64 v109, v[52:53] offset:224
    s_mov_b64 exec, s[36:37]
    s_cbranch_execz L_sg7
    v_cmp_le_u32 vcc, 56, v59
    v_lshl_add_u32 v141, v59, 2, v110
    v_lshl_add_u32 v110, v59, 3, v110
    s_cbranch_vccnz L_fx10
L_fr10:
    ds_write_b32 v141, v58
    ds_write_b64 v110, v[56:57] offset:224
    s_mov_b64 exec, s[38:39]
    s_cbranch_execz L_sg7
    v_cmp_le_u32 vcc, 56, v63
    v_lshl_add_u32 v141, v63, 2, v111
    v_lshl_add_u32 v111, v63, 3, v111
    s_cbranch_vccnz L_fx11
L_fr11:
    ds_write_b32 v141, v62
    ds_write_b64 v111, v[60:61] offset:224
    s_mov_b64 exec, s[40:41]
    s_cbranch_execz L_sg7
    v_cmp_le_u32 vcc, 56, v67
    v_lshl_add_u32 v141, v67, 2, v112
    v_lshl_add_u32 v112, v67, 3, v112
    s_cbranch_vccnz L_fx12
L_fr12:
    ds_write_b32 v141, v66
    ds_write_b64 v112, v[64:65] offset:224
L_sg7:
    s_mov_b64 exec, s[42:43]
    v_cmp_le_u32 vcc, 56, v71
    v_lshl_add_u32 v141, v71, 2, v113
    v_lshl_add_u32 v113, v71, 3, v113
    s_cbranch_vccnz L_fx14
L_fr14:
    ds_write_b32 v141, v70
    ds_write_b64 v113, v[68:69] offset:224
    s_mov_b64 exec, s[44:45]
    v_cmp_le_u32 vcc, 56, v75
    v_lshl_add_u32 v141, v75, 2, v114
    v_lshl_add_u32 v114, v75, 3, v114
    s_cbranch_vccnz L_fx15
L_fr15:
    ds_write_b32 v141, v74
    ds_write_b64 v114, v[72:73] offset:224
    s_mov_b64 exec, s[46:47]
    s_cbranch_execz L_sg13
    v_cmp_le_u32 vcc, 56, v79
    v_lshl_add_u32 v141, v79, 2, v115
    v_lshl_add_u32 v115, v79, 3, v115
    s_cbranch_vccnz L_fx16
L_fr16:
    ds_write_b32 v141, v78
    ds_write_b64 v115, v[76:77] offset:224
    s_mov_b64 exec, s[48:49]
    s_cbranch_execz L_sg13
    v_cmp_le_u32 vcc, 56, v83
    v_lshl_add_u32 v141, v83, 2, v116
    v_lshl_add_u32 v116, v83, 3, v116
    s_cbranch_vccnz L_fx17
L_fr17:
    ds_write_b32 v141, v82
    ds_write_b64 v116, v[80:81] offset:224
    s_mov_b64 exec, s[50:51]
    s_cbranch_execz L_sg13
    v_cmp_le_u32 vcc, 56, v87
    v_lshl_add_u32 v141, v87, 2, v117
    v_lshl_add_u32 v117, v87, 3, v117
    s_cbranch_vccnz L_fx18
L_fr18:
    ds_write_b32 v141, v86
    ds_write_b64 v117, v[84:85] offset:224
L_sg13:
    s_mov_b64 exec, s[52:53]
    s_cbranch_execz L_sg19
    v_cmp_le_u32 vcc, 56, v91
    v_lshl_add_u32 v141, v91, 2, v118
    v_lshl_add_u32 v118, v91, 3, v118
    s_cbranch_vccnz L_fx20
L_fr20:
    ds_write_b32 v141, v90
    ds_write_b64 v118, v[88:89] offset:224
    s_mov_b64 exec, s[54:55]
    v_cmp_le_u32 vcc, 56, v95
    v_lshl_add_u32 v141, v95, 2, v119
    v_lshl_add_u32 v119, v95, 3, v119
    s_cbranch_vccnz L_fx21
L_fr21:
    ds_write_b32 v141, v94
    ds_write_b64 v119, v[92:93] offset:224
    s_mov_b64 exec, s[56:57]
    s_cbranch_execz L_sg19
    v_cmp_le_u32 vcc, 56, v99
    v_lshl_add_u32 v141, v99, 2, v120
    v_lshl_add_u32 v120, v99, 3, v120
    s_cbranch_vccnz L_fx22
L_fr22:
    ds_write_b32 v141, v98
    ds_write_b64 v120, v[96:97] offset:224
    s_mov_b64 exec, s[58:59]
    s_cbranch_execz L_sg19
    v_cmp_le_u32 vcc, 56, v103
    v_lshl_add_u32 v141, v103, 2, v121
    v_lshl_add_u32 v121, v103, 3, v121
    s_cbranch_vccnz L_fx23
L_fr23:
    ds_write_b32 v141, v102
    ds_write_b64 v121, v[100:101] offset:224
    s_mov_b64 exec, s[60:61]
    s_cbranch_execz L_sg19
    v_cmp_le_u32 vcc, 56, v107
    v_lshl_add_u32 v141, v107, 2, v122
    v_lshl_add_u32 v122, v107, 3, v122
    s_cbranch_vccnz L_fx24
L_fr24:
    ds_write_b32 v141, v106
    ds_write_b64 v122, v[104:105] offset:224
L_sg19:
    s_mov_b64 exec, -1
    s_lshr_b32 s88, s2, 3
    s_mul_i32 s88, s88, 12
    s_add_u32 s88, s88, s63
    s_mul_i32 s88, s88, 2048
    s_add_u32 s88, s88, 1258356736
    s_and_b32 s89, s2, 4
    s_xor_b32 s89, s89, 4
    s_mul_i32 s89, s89, 0
    s_add_u32 s88, s88, s89
    v_lshlrev_b32 v41, 7, v1
    s_mov_b32 exec_lo, 65535
    s_mov_b32 exec_hi, 0
    buffer_load_dword v41, v41, s[8:11], s88 offen sc1
    s_mov_b64 exec, -1
    s_waitcnt lgkmcnt(0)
    s_barrier
    ds_read_b64 v[50:51], v152 offset:0
    ds_read_b32 v49, v153 offset:1040
    s_mov_b32 s90, 0x80000004
    s_lshl_b32 s91, s63, 2
    s_waitcnt lgkmcnt(0)
    v_add_u32 v80, -1, v50
    v_add_u32 v81, -1, v51
    v_and_b32 v80, s90, v80
    v_and_b32 v81, s90, v81
    v_cmp_gt_u32 s[84:85], 56, v50
    v_cmp_gt_u32 s[86:87], 56, v51
    v_cmp_eq_u32 vcc, 0, v80
    v_cmp_eq_u32 s[32:33], 0, v81
    v_add_u32 v52, 7, v50
    v_add_u32 v53, 7, v51
    s_and_b64 s[84:85], s[84:85], vcc
    s_and_b64 s[86:87], s[86:87], s[32:33]
    s_bcnt1_i32_b64 s88, s[84:85]
    v_mbcnt_lo_u32_b32 v82, s84, 0
    v_mov_b32 v83, s88
    v_mbcnt_hi_u32_b32 v82, s85, v82
    v_mbcnt_lo_u32_b32 v83, s86, v83
    v_mbcnt_hi_u32_b32 v83, s87, v83
    v_subrev_u32 v84, s91, v82
    v_subrev_u32 v85, s91, v83
    v_cmp_gt_u32 s[32:33], 4, v84
    v_cmp_gt_u32 s[34:35], 4, v85
    v_cmp_gt_u32 s[36:37], 48, v82
    v_cmp_gt_u32 s[38:39], 48, v83
    s_and_b64 exec, s[84:85], s[32:33]
    s_cbranch_execz L_shs0
    v_and_b32 v86, 0x78, v50
    v_and_b32 v90, 7, v50
    v_lshl_add_u32 v88, v86, 2, v32
    v_lshl_add_u32 v89, v86, 3, v32
    v_lshlrev_b32 v90, 3, v90
    v_mov_b32 v91, v34
    v_add_u32 v89, 224, v89
    v_sub_u32 v90, 64, v90
    v_lshlrev_b32 v87, 4, v82
    ds_write_b128 v87, v[88:91] offset:1600
L_shs0:
    s_and_b64 exec, s[86:87], s[34:35]
    s_cbranch_execz L_shs1
    v_and_b32 v86, 0x78, v51
    v_and_b32 v90, 7, v51
    v_lshl_add_u32 v88, v86, 2, v33
    v_lshl_add_u32 v89, v86, 3, v33
    v_lshlrev_b32 v90, 3, v90
    v_mov_b32 v91, v35
    v_add_u32 v89, 224, v89
    v_sub_u32 v90, 64, v90
    v_lshlrev_b32 v87, 4, v83
    ds_write_b128 v87, v[88:91] offset:1600
L_shs1:
    s_mov_b64 exec, -1
    ds_read2_b32 v[14:15], v4 offset0:1 offset1:0
    ds_read_u16 v11, v5
    ds_read_u16 v36, v2 offset:0
    ds_read_u16 v37, v3 offset:0
    s_and_b64 s[84:85], s[84:85], s[36:37]
    s_and_b64 s[86:87], s[86:87], s[38:39]
    v_lshrrev_b32 v52, 3, v52
    v_lshrrev_b32 v53, 3, v53
    v_subb_co_u32 v52, vcc, v52, 0, s[84:85]
    v_subb_co_u32 v53, vcc, v53, 0, s[86:87]
    v_add_u32 v56, v52, v53
    v_max_u32 v55, v52, v53
    v_cmp_lt_u32 s[32:33], 56, v50
    v_cmp_lt_u32 s[34:35], 56, v51
    v_add_u32_dpp v56, v56, v56 row_shr:1 row_mask:0xf bank_mask:0xf bound_ctrl:0
    v_max_u32_dpp v55, v55, v55 row_shr:1 row_mask:0xf bank_mask:0xf bound_ctrl:0
    v_readfirstlane_b32 s71, v49
    v_add_u32_dpp v56, v56, v56 row_shr:2 row_mask:0xf bank_mask:0xf bound_ctrl:0
    v_max_u32_dpp v55, v55, v55 row_shr:2 row_mask:0xf bank_mask:0xf bound_ctrl:0
    s_waitcnt lgkmcnt(3)
    v_lshl_add_u64 v[14:15], v[14:15], 0, v[6:7]
    ds_read_b32 v38, v15
    ds_read_b64 v[16:17], v14
    v_add_u32_dpp v56, v56, v56 row_shr:4 row_mask:0xf bank_mask:0xf bound_ctrl:0
    v_max_u32_dpp v55, v55, v55 row_shr:4 row_mask:0xf bank_mask:0xf bound_ctrl:0
    v_cndmask_b32 v58, v52, 0, s[28:29]
    v_add_u32_dpp v56, v56, v56 row_shr:8 row_mask:0xf bank_mask:0xf bound_ctrl:0
    v_max_u32_dpp v55, v55, v55 row_shr:8 row_mask:0xf bank_mask:0xf bound_ctrl:0
    v_add_u32 v58, v58, v53
    v_add_u32_dpp v56, v56, v56 row_bcast:15 row_mask:0xa bank_mask:0xf
    v_max_u32_dpp v55, v55, v55 row_bcast:15 row_mask:0xa bank_mask:0xf
    v_cndmask_b32 v50, v50, v51, s[28:29]
    v_add_u32_dpp v56, v56, v56 row_bcast:31 row_mask:0xc bank_mask:0xf
    v_max_u32_dpp v55, v55, v55 row_bcast:31 row_mask:0xc bank_mask:0xf
    v_cndmask_b32 v52, v52, v53, s[28:29]
    s_waitcnt lgkmcnt(1)
    v_mfma_f32_32x32x8_f16 v[128:143], v[38:39], v[30:31], 0
    v_add_u32_dpp v10, v11, v44 quad_perm:[0,1,2,3] row_mask:0xc bank_mask:0xf
    v_lshl_add_u64 v[12:13], v[36:37], 0, v[8:9]
    v_readlane_b32 s65, v56, 63
    v_readlane_b32 s70, v55, 63
    v_sub_u32 v56, v56, v58
    ds_read_b64_tr_b16 v[18:19], v10
    ds_read_b64_tr_b16 v[20:21], v10 offset:64
    ds_read_b64_tr_b16 v[22:23], v10 offset:128
    ds_read_b64_tr_b16 v[24:25], v10 offset:192
    s_bcnt1_i32_b64 s89, s[32:33]
    s_bcnt1_i32_b64 s90, s[34:35]
    s_add_u32 s89, s89, s90
    s_cmp_gt_u32 s89, 1
    s_cselect_b32 s71, 1, s71
    buffer_load_dword v96, v128, s[8:11], 0 offen sc1
    buffer_load_dword v97, v129, s[8:11], 0 offen sc1
    buffer_load_dword v98, v130, s[8:11], 0 offen sc1
    buffer_load_dword v99, v131, s[8:11], 0 offen sc1
    buffer_load_dword v100, v132, s[8:11], 0 offen sc1
    buffer_load_dword v101, v133, s[8:11], 0 offen sc1
    buffer_load_dword v102, v134, s[8:11], 0 offen sc1
    buffer_load_dword v103, v135, s[8:11], 0 offen sc1
    buffer_load_dword v120, v128, s[8:11], 0 offen offset:128 sc1
    buffer_load_dword v121, v129, s[8:11], 0 offen offset:128 sc1
    buffer_load_dword v122, v130, s[8:11], 0 offen offset:128 sc1
    buffer_load_dword v123, v131, s[8:11], 0 offen offset:128 sc1
    buffer_load_dword v124, v132, s[8:11], 0 offen offset:128 sc1
    buffer_load_dword v125, v133, s[8:11], 0 offen offset:128 sc1
    buffer_load_dword v126, v134, s[8:11], 0 offen offset:128 sc1
    buffer_load_dword v127, v135, s[8:11], 0 offen offset:128 sc1
    s_cmp_gt_u32 s65, 432
    s_cselect_b32 s71, 1, s71
    s_cmp_gt_u32 s70, 9
    s_cselect_b32 s71, 1, s71
    s_cmp_lg_u32 s71, 0
    s_cbranch_scc1 L_slow
L_build:
    s_lshl_b32 s88, s30, 6
    s_add_u32 s88, s88, 64
    s_lshl_b32 s89, s30, 4
    v_cmp_lt_u32 vcc, s30, v52
    v_mad_i32_i24 v146, v50, -8, s88
    v_lshl_add_u32 v57, v56, 4, s89
    v_max_i32 v146, 0, v146
    s_and_b64 exec, exec, vcc
    ds_write_b128 v57, v[144:147] offset:2384
    s_mov_b64 exec, -1
    s_add_u32 s30, s30, 6
    s_cmp_lt_u32 s30, s70
    s_cbranch_scc1 L_build2
    s_add_u32 s88, s65, 3
    s_lshr_b32 s88, s88, 2
    s_mul_i32 s66, s88, 171
    s_lshr_b32 s66, s66, 11
    s_mul_i32 s89, s66, 12
    s_sub_u32 s67, s88, s89
    s_cmp_gt_u32 s70, s66
    s_cselect_b32 s66, s70, s66
    s_cselect_b32 s67, 0, s67
    s_cmp_lt_u32 s63, s67
    s_addc_u32 s64, s66, 0
    s_min_u32 s88, s63, s67
    s_mul_i32 s89, s66, s63
    s_add_u32 s89, s89, s88
    s_lshl_b32 s89, s89, 2
    s_min_u32 s89, s89, s65
    s_lshl_b32 s90, s64, 4
    s_sub_u32 s90, s90, 16
    s_lshl_b32 s68, s89, 4
    s_add_u32 s68, s68, 2384
    s_sub_u32 s84, s68, s74
    s_mov_b32 s85, s84
    v_mad_i32_i24 v2, v148, s90, v2
    v_mad_i32_i24 v3, v149, s90, v3
    v_mad_i32_i24 v4, v150, s90, v4
    v_mad_i32_i24 v5, v151, s90, v5
    v_lshl_add_u64 v[2:3], v[2:3], 0, s[84:85]
    v_lshl_add_u64 v[4:5], v[4:5], 0, s[84:85]
    v_lshl_add_u32 v60, v1, 4, s68
    v_mov_b32 v61, s68
    s_sub_u32 s89, s65, s89
    s_cmp_lg_u32 s89, 0
    s_addc_u32 s89, s89, 0
    s_min_u32 s64, s64, s89
    s_waitcnt lgkmcnt(0)
    s_barrier
    v_mov_b32 v47, 0
    v_mov_b32 v42, v60
    v_add_u32 v43, -2, v61
    s_movk_i32 s88, 3840
    s_bitcmp1_b32 s88, s63
    s_cbranch_scc1 L_c1
    ds_read_b32 v26, v4
    ds_read_u16 v36, v42 offset:14
    ds_read_u16 v37, v43
    ds_read2_b32 v[14:15], v4 offset0:1 offset1:4
    ds_read_u16 v11, v5
    s_add_u32 s88, s63, 98
    s_mul_i32 s88, s88, 528
    v_cmp_gt_u32 s[84:85], s64, v1
    s_waitcnt lgkmcnt(4)
    v_add_u32 v26, v26, v7
    ds_read_b32 v38, v26
    s_waitcnt lgkmcnt(3)
    v_cmp_eq_u32 vcc, v36, v37
    v_mov_b32 v43, s88
    s_and_b64 s[84:85], s[84:85], vcc
    s_waitcnt lgkmcnt(0)
    v_mfma_f32_32x32x8_f16 v[128:143], v[38:39], v[30:31], 0
    v_lshl_add_u64 v[14:15], v[14:15], 0, v[6:7]
    v_add_u32_dpp v10, v11, v44 quad_perm:[0,1,2,3] row_mask:0xc bank_mask:0xf
    s_mov_b64 exec, s[84:85]
    ds_write_b16 v42, v43 offset:12
    s_mov_b64 exec, -1
    ds_read_b32 v38, v15
    ds_read_u16 v36, v2 offset:0
    ds_read_u16 v37, v3 offset:0
    s_nop 4
L_c1:
    s_movk_i32 s88, 15
    s_bitcmp1_b32 s88, s63
    s_cbranch_scc0 L_fp00
    buffer_load_dword v48, v128, s[8:11], 0 offen offset:0 sc1
    buffer_load_dword v49, v129, s[8:11], 0 offen offset:0 sc1
    buffer_load_dword v50, v130, s[8:11], 0 offen offset:0 sc1
    buffer_load_dword v51, v131, s[8:11], 0 offen offset:0 sc1
    buffer_load_dword v52, v132, s[8:11], 0 offen offset:0 sc1
    buffer_load_dword v53, v133, s[8:11], 0 offen offset:0 sc1
    buffer_load_dword v54, v134, s[8:11], 0 offen offset:0 sc1
    buffer_load_dword v55, v135, s[8:11], 0 offen offset:0 sc1
    buffer_load_dword v56, v136, s[8:11], 0 offen offset:0 sc1
    buffer_load_dword v57, v137, s[8:11], 0 offen offset:0 sc1
    buffer_load_dword v58, v138, s[8:11], 0 offen offset:0 sc1
    buffer_load_dword v59, v139, s[8:11], 0 offen offset:0 sc1
    buffer_load_dword v60, v140, s[8:11], 0 offen offset:0 sc1
    buffer_load_dword v61, v141, s[8:11], 0 offen offset:0 sc1
    buffer_load_dword v62, v142, s[8:11], 0 offen offset:0 sc1
    buffer_load_dword v63, v143, s[8:11], 0 offen offset:0 sc1
L_fp00:
    s_movk_i32 s88, 4080
    s_bitcmp1_b32 s88, s63
    s_cbranch_scc0 L_wa0
    s_waitcnt vmcnt(0)
L_wa0:
    s_movk_i32 s88, 15
    s_bitcmp1_b32 s88, s63
    s_cbranch_scc0 L_wa1
    s_waitcnt vmcnt(16)
L_wa1:
    v_lshlrev_b64 v[80:81], 16, v[96:97]
    v_lshlrev_b64 v[82:83], 16, v[98:99]
    v_lshlrev_b64 v[84:85], 16, v[100:101]
    v_lshlrev_b64 v[86:87], 16, v[102:103]
    s_nop 1
    v_mfma_f32_32x32x8_bf16 v[80:95], v[16:17], v[18:19], v[80:95]
    v_mfma_f32_32x32x8_bf16 v[96:111], v[16:17], v[20:21], v[96:111]
    s_nop 10
    v_exp_f32 v112, v80
    v_exp_f32 v113, v81
    v_exp_f32 v114, v82
    v_exp_f32 v115, v83
    v_exp_f32 v116, v84
    v_exp_f32 v117, v85
    v_exp_f32 v118, v86
    v_exp_f32 v119, v87
    v_pk_add_f32 v[144:145], v[112:113], s[78:79]
    v_pk_fma_f32 v[146:147], v[80:81], v[114:115], v[80:81]
    v_pk_fma_f32 v[146:147], v[82:83], v[144:145], v[146:147]
    v_pk_fma_f32 v[144:145], v[144:145], v[114:115], v[144:145]
    v_pk_fma_f32 v[146:147], v[146:147], v[116:117], v[146:147]
    v_pk_fma_f32 v[146:147], v[84:85], v[144:145], v[146:147]
    v_pk_fma_f32 v[144:145], v[144:145], v[116:117], v[144:145]
    v_pk_fma_f32 v[146:147], v[146:147], v[118:119], v[146:147]
    v_pk_fma_f32 v[146:147], v[86:87], v[144:145], v[146:147]
    v_pk_fma_f32 v[144:145], v[144:145], v[118:119], v[144:145]
    v_exp_f32 v112, v96
    v_exp_f32 v113, v97
    v_exp_f32 v114, v98
    v_exp_f32 v115, v99
    v_exp_f32 v116, v100
    v_exp_f32 v117, v101
    v_exp_f32 v118, v102
    v_exp_f32 v119, v103
    v_pk_add_f32 v[148:149], v[112:113], s[78:79]
    v_pk_fma_f32 v[150:151], v[96:97], v[114:115], v[96:97]
    v_pk_fma_f32 v[150:151], v[98:99], v[148:149], v[150:151]
    v_pk_fma_f32 v[148:149], v[148:149], v[114:115], v[148:149]
    v_pk_fma_f32 v[150:151], v[150:151], v[116:117], v[150:151]
    v_pk_fma_f32 v[150:151], v[100:101], v[148:149], v[150:151]
    v_pk_fma_f32 v[148:149], v[148:149], v[116:117], v[148:149]
    v_pk_fma_f32 v[150:151], v[150:151], v[118:119], v[150:151]
    v_pk_fma_f32 v[150:151], v[102:103], v[148:149], v[150:151]
    v_pk_fma_f32 v[148:149], v[148:149], v[118:119], v[148:149]
    v_pk_mul_f32 v[26:27], v[144:145], v[148:149]
    v_rcp_f32 v112, v26
    v_rcp_f32 v113, v27
    v_pk_mul_f32 v[146:147], v[146:147], v[148:149]
    v_pk_mul_f32 v[150:151], v[150:151], v[144:145]
    v_max3_f32 v28, v26, v27, v28
    v_pk_mul_f32 v[160:161], v[146:147], v[112:113]
    v_pk_mul_f32 v[162:163], v[150:151], v[112:113]
    ds_write2_b32 v12, v160, v162 offset0:0 offset1:32
    ds_write2_b32 v13, v161, v163 offset0:0 offset1:32
    s_movk_i32 s88, 240
    s_bitcmp1_b32 s88, s63
    s_cbranch_scc0 L_fp10
    buffer_load_dword v48, v128, s[8:11], 0 offen offset:0 sc1
    buffer_load_dword v49, v129, s[8:11], 0 offen offset:0 sc1
    buffer_load_dword v50, v130, s[8:11], 0 offen offset:0 sc1
    buffer_load_dword v51, v131, s[8:11], 0 offen offset:0 sc1
    buffer_load_dword v52, v132, s[8:11], 0 offen offset:0 sc1
    buffer_load_dword v53, v133, s[8:11], 0 offen offset:0 sc1
    buffer_load_dword v54, v134, s[8:11], 0 offen offset:0 sc1
    buffer_load_dword v55, v135, s[8:11], 0 offen offset:0 sc1
    buffer_load_dword v56, v136, s[8:11], 0 offen offset:0 sc1
    buffer_load_dword v57, v137, s[8:11], 0 offen offset:0 sc1
    buffer_load_dword v58, v138, s[8:11], 0 offen offset:0 sc1
    buffer_load_dword v59, v139, s[8:11], 0 offen offset:0 sc1
    buffer_load_dword v60, v140, s[8:11], 0 offen offset:0 sc1
    buffer_load_dword v61, v141, s[8:11], 0 offen offset:0 sc1
    buffer_load_dword v62, v142, s[8:11], 0 offen offset:0 sc1
    buffer_load_dword v63, v143, s[8:11], 0 offen offset:0 sc1
L_fp10:
    s_movk_i32 s88, 15
    s_bitcmp1_b32 s88, s63
    s_cbranch_scc0 L_fp11
    buffer_load_dword v64, v128, s[8:11], 0 offen offset:128 sc1
    buffer_load_dword v65, v129, s[8:11], 0 offen offset:128 sc1
    buffer_load_dword v66, v130, s[8:11], 0 offen offset:128 sc1
    buffer_load_dword v67, v131, s[8:11], 0 offen offset:128 sc1
    buffer_load_dword v68, v132, s[8:11], 0 offen offset:128 sc1
    buffer_load_dword v69, v133, s[8:11], 0 offen offset:128 sc1
    buffer_load_dword v70, v134, s[8:11], 0 offen offset:128 sc1
    buffer_load_dword v71, v135, s[8:11], 0 offen offset:128 sc1
    buffer_load_dword v72, v136, s[8:11], 0 offen offset:128 sc1
    buffer_load_dword v73, v137, s[8:11], 0 offen offset:128 sc1
    buffer_load_dword v74, v138, s[8:11], 0 offen offset:128 sc1
    buffer_load_dword v75, v139, s[8:11], 0 offen offset:128 sc1
    buffer_load_dword v76, v140, s[8:11], 0 offen offset:128 sc1
    buffer_load_dword v77, v141, s[8:11], 0 offen offset:128 sc1
    buffer_load_dword v78, v142, s[8:11], 0 offen offset:128 sc1
    buffer_load_dword v79, v143, s[8:11], 0 offen offset:128 sc1
L_fp11:
    v_lshlrev_b64 v[80:81], 16, v[120:121]
    v_lshlrev_b64 v[82:83], 16, v[122:123]
    v_lshlrev_b64 v[84:85], 16, v[124:125]
    v_lshlrev_b64 v[86:87], 16, v[126:127]
    s_nop 1
    v_mfma_f32_32x32x8_bf16 v[80:95], v[16:17], v[22:23], v[80:95]
    v_mfma_f32_32x32x8_bf16 v[96:111], v[16:17], v[24:25], v[120:135]
    s_nop 10
    v_exp_f32 v112, v80
    v_exp_f32 v113, v81
    v_exp_f32 v114, v82
    v_exp_f32 v115, v83
    v_exp_f32 v116, v84
    v_exp_f32 v117, v85
    v_exp_f32 v118, v86
    v_exp_f32 v119, v87
    v_pk_add_f32 v[152:153], v[112:113], s[78:79]
    v_pk_fma_f32 v[154:155], v[80:81], v[114:115], v[80:81]
    v_pk_fma_f32 v[154:155], v[82:83], v[152:153], v[154:155]
    v_pk_fma_f32 v[152:153], v[152:153], v[114:115], v[152:153]
    v_pk_fma_f32 v[154:155], v[154:155], v[116:117], v[154:155]
    v_pk_fma_f32 v[154:155], v[84:85], v[152:153], v[154:155]
    v_pk_fma_f32 v[152:153], v[152:153], v[116:117], v[152:153]
    v_pk_fma_f32 v[154:155], v[154:155], v[118:119], v[154:155]
    v_pk_fma_f32 v[154:155], v[86:87], v[152:153], v[154:155]
    v_pk_fma_f32 v[152:153], v[152:153], v[118:119], v[152:153]
    v_exp_f32 v112, v96
    v_exp_f32 v113, v97
    v_exp_f32 v114, v98
    v_exp_f32 v115, v99
    v_exp_f32 v116, v100
    v_exp_f32 v117, v101
    v_exp_f32 v118, v102
    v_exp_f32 v119, v103
    v_pk_add_f32 v[156:157], v[112:113], s[78:79]
    v_pk_fma_f32 v[158:159], v[96:97], v[114:115], v[96:97]
    v_pk_fma_f32 v[158:159], v[98:99], v[156:157], v[158:159]
    v_pk_fma_f32 v[156:157], v[156:157], v[114:115], v[156:157]
    v_pk_fma_f32 v[158:159], v[158:159], v[116:117], v[158:159]
    v_pk_fma_f32 v[158:159], v[100:101], v[156:157], v[158:159]
    v_pk_fma_f32 v[156:157], v[156:157], v[116:117], v[156:157]
    v_pk_fma_f32 v[158:159], v[158:159], v[118:119], v[158:159]
    v_pk_fma_f32 v[158:159], v[102:103], v[156:157], v[158:159]
    v_pk_fma_f32 v[156:157], v[156:157], v[118:119], v[156:157]
    v_pk_mul_f32 v[26:27], v[152:153], v[156:157]
    v_rcp_f32 v112, v26
    v_rcp_f32 v113, v27
    v_pk_mul_f32 v[154:155], v[154:155], v[156:157]
    v_pk_mul_f32 v[158:159], v[158:159], v[152:153]
    v_max3_f32 v28, v26, v27, v28
    v_pk_mul_f32 v[164:165], v[154:155], v[112:113]
    v_pk_mul_f32 v[166:167], v[158:159], v[112:113]
    ds_write2_b32 v12, v164, v166 offset0:64 offset1:96
    ds_write2_b32 v13, v165, v167 offset0:64 offset1:96
    s_mov_b64 exec, 1
    ds_add_u32 v47, v46 offset:1024
    s_mov_b64 exec, -1
    s_movk_i32 s88, 3840
    s_bitcmp1_b32 s88, s63
    s_cbranch_scc0 L_c2
    ds_read_b32 v26, v4
    ds_read_u16 v36, v42 offset:14
    ds_read_u16 v37, v43
    ds_read2_b32 v[14:15], v4 offset0:1 offset1:4
    ds_read_u16 v11, v5
    s_add_u32 s88, s63, 98
    s_mul_i32 s88, s88, 528
    v_cmp_gt_u32 s[84:85], s64, v1
    s_waitcnt lgkmcnt(4)
    v_add_u32 v26, v26, v7
    ds_read_b32 v38, v26
    s_waitcnt lgkmcnt(3)
    v_cmp_eq_u32 vcc, v36, v37
    v_mov_b32 v43, s88
    s_and_b64 s[84:85], s[84:85], vcc
    s_waitcnt lgkmcnt(0)
    v_mfma_f32_32x32x8_f16 v[128:143], v[38:39], v[30:31], 0
    v_lshl_add_u64 v[14:15], v[14:15], 0, v[6:7]
    v_add_u32_dpp v10, v11, v44 quad_perm:[0,1,2,3] row_mask:0xc bank_mask:0xf
    s_mov_b64 exec, s[84:85]
    ds_write_b16 v42, v43 offset:12
    s_mov_b64 exec, -1
    ds_read_b32 v38, v15
    ds_read_u16 v36, v2 offset:0
    ds_read_u16 v37, v3 offset:0
    s_nop 4
L_c2:
    s_movk_i32 s88, 3840
    s_bitcmp1_b32 s88, s63
    s_cbranch_scc0 L_fp20
    buffer_load_dword v48, v128, s[8:11], 0 offen offset:0 sc1
    buffer_load_dword v49, v129, s[8:11], 0 offen offset:0 sc1
    buffer_load_dword v50, v130, s[8:11], 0 offen offset:0 sc1
    buffer_load_dword v51, v131, s[8:11], 0 offen offset:0 sc1
    buffer_load_dword v52, v132, s[8:11], 0 offen offset:0 sc1
    buffer_load_dword v53, v133, s[8:11], 0 offen offset:0 sc1
    buffer_load_dword v54, v134, s[8:11], 0 offen offset:0 sc1
    buffer_load_dword v55, v135, s[8:11], 0 offen offset:0 sc1
    buffer_load_dword v56, v136, s[8:11], 0 offen offset:0 sc1
    buffer_load_dword v57, v137, s[8:11], 0 offen offset:0 sc1
    buffer_load_dword v58, v138, s[8:11], 0 offen offset:0 sc1
    buffer_load_dword v59, v139, s[8:11], 0 offen offset:0 sc1
    buffer_load_dword v60, v140, s[8:11], 0 offen offset:0 sc1
    buffer_load_dword v61, v141, s[8:11], 0 offen offset:0 sc1
    buffer_load_dword v62, v142, s[8:11], 0 offen offset:0 sc1
    buffer_load_dword v63, v143, s[8:11], 0 offen offset:0 sc1
L_fp20:
    s_movk_i32 s88, 4080
    s_bitcmp1_b32 s88, s63
    s_cbranch_scc0 L_fp21
    buffer_load_dword v64, v128, s[8:11], 0 offen offset:128 sc1
    buffer_load_dword v65, v129, s[8:11], 0 offen offset:128 sc1
    buffer_load_dword v66, v130, s[8:11], 0 offen offset:128 sc1
    buffer_load_dword v67, v131, s[8:11], 0 offen offset:128 sc1
    buffer_load_dword v68, v132, s[8:11], 0 offen offset:128 sc1
    buffer_load_dword v69, v133, s[8:11], 0 offen offset:128 sc1
    buffer_load_dword v70, v134, s[8:11], 0 offen offset:128 sc1
    buffer_load_dword v71, v135, s[8:11], 0 offen offset:128 sc1
    buffer_load_dword v72, v136, s[8:11], 0 offen offset:128 sc1
    buffer_load_dword v73, v137, s[8:11], 0 offen offset:128 sc1
    buffer_load_dword v74, v138, s[8:11], 0 offen offset:128 sc1
    buffer_load_dword v75, v139, s[8:11], 0 offen offset:128 sc1
    buffer_load_dword v76, v140, s[8:11], 0 offen offset:128 sc1
    buffer_load_dword v77, v141, s[8:11], 0 offen offset:128 sc1
    buffer_load_dword v78, v142, s[8:11], 0 offen offset:128 sc1
    buffer_load_dword v79, v143, s[8:11], 0 offen offset:128 sc1
L_fp21:
    ds_read_b64 v[16:17], v14
    ds_read_b64_tr_b16 v[18:19], v10
    ds_read_b64_tr_b16 v[20:21], v10 offset:64
    s_waitcnt lgkmcnt(0)
    s_cmp_eq_u32 s64, 0
    s_cbranch_scc1 L_loop_done
    v_mfma_f32_32x32x8_f16 v[128:143], v[38:39], v[30:31], 0
    s_waitcnt vmcnt(16)
    v_lshlrev_b64 v[80:81], 16, v[48:49]
    v_lshlrev_b64 v[82:83], 16, v[50:51]
    v_lshlrev_b64 v[84:85], 16, v[52:53]
    v_lshlrev_b64 v[86:87], 16, v[54:55]
    v_lshlrev_b64 v[88:89], 16, v[56:57]
    v_lshlrev_b64 v[90:91], 16, v[58:59]
    v_lshlrev_b64 v[92:93], 16, v[60:61]
    v_lshlrev_b64 v[94:95], 16, v[62:63]
    s_nop 1
    v_mfma_f32_32x32x8_bf16 v[80:95], v[16:17], v[18:19], v[80:95]
    s_mov_b32 s69, s64
    s_setprio 3
    s_mov_b32 s93, 0
    s_mov_b32 s92, 8
    s_nop 15
    s_cmp_eq_u32 s69, 1
    s_cbranch_scc1 L_final
.p2align 6
L_loop:
    ds_read_b64_tr_b16 v[18:19], v10 offset:128
    s_waitcnt lgkmcnt(3)
    v_mfma_f32_32x32x8_bf16 v[96:111], v[16:17], v[20:21], v[48:63]
    v_lshl_add_u64 v[12:13], v[36:37], 0, v[8:9]
    v_exp_f32 v112, v80
    v_exp_f32 v113, v81
    v_exp_f32 v114, v82
    v_exp_f32 v115, v83
    v_exp_f32 v116, v84
    v_exp_f32 v117, v85
    v_exp_f32 v118, v86
    v_exp_f32 v119, v87
    buffer_load_dword v48, v128, s[8:11], 0 offen offset:0 sc1
    buffer_load_dword v49, v129, s[8:11], 0 offen offset:0 sc1
    buffer_load_dword v50, v130, s[8:11], 0 offen offset:0 sc1
    buffer_load_dword v51, v131, s[8:11], 0 offen offset:0 sc1
    buffer_load_dword v52, v132, s[8:11], 0 offen offset:0 sc1
    buffer_load_dword v53, v133, s[8:11], 0 offen offset:0 sc1
    v_exp_f32 v120, v88
    v_exp_f32 v121, v89
    v_exp_f32 v122, v90
    v_exp_f32 v123, v91
    v_exp_f32 v124, v92
    v_exp_f32 v125, v93
    v_exp_f32 v126, v94
    v_exp_f32 v127, v95
    v_pk_add_f32 v[144:145], v[112:113], s[78:79]
    v_pk_fma_f32 v[146:147], v[80:81], v[114:115], v[80:81]
    v_pk_fma_f32 v[146:147], v[82:83], v[144:145], v[146:147]
    v_pk_fma_f32 v[144:145], v[144:145], v[114:115], v[144:145]
    buffer_load_dword v54, v134, s[8:11], 0 offen offset:0 sc1
    buffer_load_dword v55, v135, s[8:11], 0 offen offset:0 sc1
    buffer_load_dword v56, v136, s[8:11], 0 offen offset:0 sc1
    buffer_load_dword v57, v137, s[8:11], 0 offen offset:0 sc1
    buffer_load_dword v58, v138, s[8:11], 0 offen offset:0 sc1
    v_pk_fma_f32 v[146:147], v[146:147], v[116:117], v[146:147]
    v_pk_fma_f32 v[146:147], v[84:85], v[144:145], v[146:147]
    v_pk_fma_f32 v[144:145], v[144:145], v[116:117], v[144:145]
    v_pk_fma_f32 v[146:147], v[146:147], v[118:119], v[146:147]
    v_pk_fma_f32 v[146:147], v[86:87], v[144:145], v[146:147]
    v_pk_fma_f32 v[144:145], v[144:145], v[118:119], v[144:145]
    v_pk_fma_f32 v[146:147], v[146:147], v[120:121], v[146:147]
    v_pk_fma_f32 v[146:147], v[88:89], v[144:145], v[146:147]
    v_pk_fma_f32 v[144:145], v[144:145], v[120:121], v[144:145]
    v_pk_fma_f32 v[146:147], v[146:147], v[122:123], v[146:147]
    v_pk_fma_f32 v[146:147], v[90:91], v[144:145], v[146:147]
    v_pk_fma_f32 v[144:145], v[144:145], v[122:123], v[144:145]
    v_pk_fma_f32 v[146:147], v[146:147], v[124:125], v[146:147]
    v_pk_fma_f32 v[146:147], v[92:93], v[144:145], v[146:147]
    v_pk_fma_f32 v[144:145], v[144:145], v[124:125], v[144:145]
    v_pk_fma_f32 v[146:147], v[146:147], v[126:127], v[146:147]
    v_pk_fma_f32 v[146:147], v[94:95], v[144:145], v[146:147]
    v_pk_fma_f32 v[144:145], v[144:145], v[126:127], v[144:145]
    s_cmp_eq_u32 s69, s64
    s_cbranch_scc1 L_own
L_own_ret:
    buffer_load_dword v59, v139, s[8:11], 0 offen offset:0 sc1
    buffer_load_dword v60, v140, s[8:11], 0 offen offset:0 sc1
    buffer_load_dword v61, v141, s[8:11], 0 offen offset:0 sc1
    buffer_load_dword v62, v142, s[8:11], 0 offen offset:0 sc1
    buffer_load_dword v63, v143, s[8:11], 0 offen offset:0 sc1
    ds_read_b32 v160, v12 offset:0
    ds_read_b32 v161, v13 offset:0
    ds_read_b32 v162, v12 offset:128
    ds_read_b32 v163, v13 offset:128
    ds_read_b64_tr_b16 v[20:21], v10 offset:192
    ds_read_u16 v36, v2 offset:16
    ds_read_u16 v37, v3 offset:16
    ds_read2_b32 v[14:15], v4 offset0:5 offset1:8
    ds_read_u16 v11, v5 offset:16
    s_waitcnt vmcnt(16)
    v_lshlrev_b64 v[80:81], 16, v[64:65]
    v_lshlrev_b64 v[82:83], 16, v[66:67]
    v_lshlrev_b64 v[84:85], 16, v[68:69]
    v_lshlrev_b64 v[86:87], 16, v[70:71]
    v_lshlrev_b64 v[88:89], 16, v[72:73]
    v_lshlrev_b64 v[90:91], 16, v[74:75]
    v_lshlrev_b64 v[92:93], 16, v[76:77]
    v_lshlrev_b64 v[94:95], 16, v[78:79]
    v_exp_f32 v112, v96
    v_exp_f32 v113, v97
    s_waitcnt lgkmcnt(9)
    v_mfma_f32_32x32x8_bf16 v[80:95], v[16:17], v[18:19], v[80:95]
    v_exp_f32 v114, v98
    v_exp_f32 v115, v99
    v_exp_f32 v116, v100
    v_exp_f32 v117, v101
    v_exp_f32 v118, v102
    v_exp_f32 v119, v103
    v_exp_f32 v120, v104
    v_exp_f32 v121, v105
    v_exp_f32 v122, v106
    v_exp_f32 v123, v107
    v_exp_f32 v124, v108
    v_exp_f32 v125, v109
    v_exp_f32 v126, v110
    v_exp_f32 v127, v111
    s_waitcnt lgkmcnt(0)
    v_add_u32_dpp v10, v11, v44 quad_perm:[0,1,2,3] row_mask:0xc bank_mask:0xf
    v_lshl_add_u64 v[14:15], v[14:15], 0, v[6:7]
    v_pk_add_f32 v[148:149], v[112:113], s[78:79]
    v_pk_fma_f32 v[150:151], v[96:97], v[114:115], v[96:97]
    v_pk_fma_f32 v[150:151], v[98:99], v[148:149], v[150:151]
    v_pk_fma_f32 v[148:149], v[148:149], v[114:115], v[148:149]
    v_pk_fma_f32 v[150:151], v[150:151], v[116:117], v[150:151]
    v_pk_fma_f32 v[150:151], v[100:101], v[148:149], v[150:151]
    v_pk_fma_f32 v[148:149], v[148:149], v[116:117], v[148:149]
    v_pk_fma_f32 v[150:151], v[150:151], v[118:119], v[150:151]
    v_pk_fma_f32 v[150:151], v[102:103], v[148:149], v[150:151]
    v_pk_fma_f32 v[148:149], v[148:149], v[118:119], v[148:149]
    v_pk_fma_f32 v[150:151], v[150:151], v[120:121], v[150:151]
    v_pk_fma_f32 v[150:151], v[104:105], v[148:149], v[150:151]
    v_pk_fma_f32 v[148:149], v[148:149], v[120:121], v[148:149]
    v_pk_fma_f32 v[150:151], v[150:151], v[122:123], v[150:151]
    v_pk_fma_f32 v[150:151], v[106:107], v[148:149], v[150:151]
    v_pk_fma_f32 v[148:149], v[148:149], v[122:123], v[148:149]
    v_pk_fma_f32 v[150:151], v[150:151], v[124:125], v[150:151]
    v_pk_fma_f32 v[150:151], v[108:109], v[148:149], v[150:151]
    v_pk_fma_f32 v[148:149], v[148:149], v[124:125], v[148:149]
    v_pk_fma_f32 v[150:151], v[150:151], v[126:127], v[150:151]
    v_pk_fma_f32 v[150:151], v[110:111], v[148:149], v[150:151]
    v_pk_fma_f32 v[148:149], v[148:149], v[126:127], v[148:149]
    v_pk_mul_f32 v[22:23], v[144:145], v[148:149]
    v_rcp_f32 v112, v22
    v_rcp_f32 v113, v23
    v_pk_mul_f32 v[146:147], v[146:147], v[148:149]
    v_pk_mul_f32 v[150:151], v[150:151], v[144:145]
    v_max3_f32 v28, v22, v23, v28
    v_pk_fma_f32 v[160:161], v[146:147], v[112:113], v[160:161]
    v_pk_fma_f32 v[162:163], v[150:151], v[112:113], v[162:163]
    ds_write2_b32 v12, v160, v162 offset0:0 offset1:32
    ds_write2_b32 v13, v161, v163 offset0:0 offset1:32
    s_bitcmp1_b32 s92, s69
    s_cbranch_scc1 L_prio2
L_prio2_ret:
    ds_read_b64_tr_b16 v[18:19], v10 offset:0
    v_mfma_f32_32x32x8_bf16 v[96:111], v[16:17], v[20:21], v[64:79]
    v_exp_f32 v112, v80
    v_exp_f32 v113, v81
    v_exp_f32 v114, v82
    v_exp_f32 v115, v83
    v_exp_f32 v116, v84
    v_exp_f32 v117, v85
    v_exp_f32 v118, v86
    v_exp_f32 v119, v87
    buffer_load_dword v64, v128, s[8:11], 0 offen offset:128 sc1
    buffer_load_dword v65, v129, s[8:11], 0 offen offset:128 sc1
    buffer_load_dword v66, v130, s[8:11], 0 offen offset:128 sc1
    buffer_load_dword v67, v131, s[8:11], 0 offen offset:128 sc1
    buffer_load_dword v68, v132, s[8:11], 0 offen offset:128 sc1
    buffer_load_dword v69, v133, s[8:11], 0 offen offset:128 sc1
    ds_read_b32 v38, v15
    ds_read_b64 v[16:17], v14
    v_exp_f32 v120, v88
    v_exp_f32 v121, v89
    v_exp_f32 v122, v90
    v_exp_f32 v123, v91
    v_exp_f32 v124, v92
    v_exp_f32 v125, v93
    v_exp_f32 v126, v94
    v_exp_f32 v127, v95
    v_pk_add_f32 v[152:153], v[112:113], s[78:79]
    v_pk_fma_f32 v[154:155], v[80:81], v[114:115], v[80:81]
    v_pk_fma_f32 v[154:155], v[82:83], v[152:153], v[154:155]
    v_pk_fma_f32 v[152:153], v[152:153], v[114:115], v[152:153]
    buffer_load_dword v70, v134, s[8:11], 0 offen offset:128 sc1
    buffer_load_dword v71, v135, s[8:11], 0 offen offset:128 sc1
    buffer_load_dword v72, v136, s[8:11], 0 offen offset:128 sc1
    buffer_load_dword v73, v137, s[8:11], 0 offen offset:128 sc1
    buffer_load_dword v74, v138, s[8:11], 0 offen offset:128 sc1
    v_pk_fma_f32 v[154:155], v[154:155], v[116:117], v[154:155]
    v_pk_fma_f32 v[154:155], v[84:85], v[152:153], v[154:155]
    v_pk_fma_f32 v[152:153], v[152:153], v[116:117], v[152:153]
    v_pk_fma_f32 v[154:155], v[154:155], v[118:119], v[154:155]
    v_pk_fma_f32 v[154:155], v[86:87], v[152:153], v[154:155]
    v_pk_fma_f32 v[152:153], v[152:153], v[118:119], v[152:153]
    v_pk_fma_f32 v[154:155], v[154:155], v[120:121], v[154:155]
    v_pk_fma_f32 v[154:155], v[88:89], v[152:153], v[154:155]
    v_pk_fma_f32 v[152:153], v[152:153], v[120:121], v[152:153]
    v_pk_fma_f32 v[154:155], v[154:155], v[122:123], v[154:155]
    v_pk_fma_f32 v[154:155], v[90:91], v[152:153], v[154:155]
    v_pk_fma_f32 v[152:153], v[152:153], v[122:123], v[152:153]
    v_pk_fma_f32 v[154:155], v[154:155], v[124:125], v[154:155]
    v_pk_fma_f32 v[154:155], v[92:93], v[152:153], v[154:155]
    v_pk_fma_f32 v[152:153], v[152:153], v[124:125], v[152:153]
    v_pk_fma_f32 v[154:155], v[154:155], v[126:127], v[154:155]
    v_pk_fma_f32 v[154:155], v[94:95], v[152:153], v[154:155]
    v_pk_fma_f32 v[152:153], v[152:153], v[126:127], v[152:153]
    buffer_load_dword v75, v139, s[8:11], 0 offen offset:128 sc1
    buffer_load_dword v76, v140, s[8:11], 0 offen offset:128 sc1
    buffer_load_dword v77, v141, s[8:11], 0 offen offset:128 sc1
    buffer_load_dword v78, v142, s[8:11], 0 offen offset:128 sc1
    buffer_load_dword v79, v143, s[8:11], 0 offen offset:128 sc1
    ds_read_b32 v164, v12 offset:256
    ds_read_b32 v165, v13 offset:256
    ds_read_b32 v166, v12 offset:384
    ds_read_b32 v167, v13 offset:384
    ds_read_b64_tr_b16 v[20:21], v10 offset:64
    s_waitcnt vmcnt(16)
    v_lshlrev_b64 v[80:81], 16, v[48:49]
    v_lshlrev_b64 v[82:83], 16, v[50:51]
    v_lshlrev_b64 v[84:85], 16, v[52:53]
    v_lshlrev_b64 v[86:87], 16, v[54:55]
    v_lshlrev_b64 v[88:89], 16, v[56:57]
    v_lshlrev_b64 v[90:91], 16, v[58:59]
    v_lshlrev_b64 v[92:93], 16, v[60:61]
    v_lshlrev_b64 v[94:95], 16, v[62:63]
    v_exp_f32 v112, v96
    v_exp_f32 v113, v97
    s_waitcnt lgkmcnt(5)
    v_mfma_f32_32x32x8_bf16 v[80:95], v[16:17], v[18:19], v[80:95]
    v_exp_f32 v114, v98
    v_exp_f32 v115, v99
    v_exp_f32 v116, v100
    v_exp_f32 v117, v101
    v_mfma_f32_32x32x8_f16 v[128:143], v[38:39], v[30:31], 0
    v_exp_f32 v118, v102
    v_exp_f32 v119, v103
    v_exp_f32 v120, v104
    v_exp_f32 v121, v105
    v_exp_f32 v122, v106
    v_exp_f32 v123, v107
    v_exp_f32 v124, v108
    v_exp_f32 v125, v109
    v_exp_f32 v126, v110
    v_exp_f32 v127, v111
    v_lshl_add_u64 v[2:3], v[2:3], 0, s[80:81]
    v_lshl_add_u64 v[4:5], v[4:5], 0, s[80:81]
    v_pk_add_f32 v[156:157], v[112:113], s[78:79]
    v_pk_fma_f32 v[158:159], v[96:97], v[114:115], v[96:97]
    v_pk_fma_f32 v[158:159], v[98:99], v[156:157], v[158:159]
    v_pk_fma_f32 v[156:157], v[156:157], v[114:115], v[156:157]
    v_pk_fma_f32 v[158:159], v[158:159], v[116:117], v[158:159]
    v_pk_fma_f32 v[158:159], v[100:101], v[156:157], v[158:159]
    v_pk_fma_f32 v[156:157], v[156:157], v[116:117], v[156:157]
    v_pk_fma_f32 v[158:159], v[158:159], v[118:119], v[158:159]
    v_pk_fma_f32 v[158:159], v[102:103], v[156:157], v[158:159]
    v_pk_fma_f32 v[156:157], v[156:157], v[118:119], v[156:157]
    v_pk_fma_f32 v[158:159], v[158:159], v[120:121], v[158:159]
    v_pk_fma_f32 v[158:159], v[104:105], v[156:157], v[158:159]
    v_pk_fma_f32 v[156:157], v[156:157], v[120:121], v[156:157]
    v_pk_fma_f32 v[158:159], v[158:159], v[122:123], v[158:159]
    v_pk_fma_f32 v[158:159], v[106:107], v[156:157], v[158:159]
    v_pk_fma_f32 v[156:157], v[156:157], v[122:123], v[156:157]
    v_pk_fma_f32 v[158:159], v[158:159], v[124:125], v[158:159]
    v_pk_fma_f32 v[158:159], v[108:109], v[156:157], v[158:159]
    v_pk_fma_f32 v[156:157], v[156:157], v[124:125], v[156:157]
    v_pk_fma_f32 v[158:159], v[158:159], v[126:127], v[158:159]
    v_pk_fma_f32 v[158:159], v[110:111], v[156:157], v[158:159]
    v_pk_fma_f32 v[156:157], v[156:157], v[126:127], v[156:157]
    v_pk_mul_f32 v[22:23], v[152:153], v[156:157]
    v_rcp_f32 v112, v22
    v_rcp_f32 v113, v23
    v_pk_mul_f32 v[154:155], v[154:155], v[156:157]
    v_pk_mul_f32 v[158:159], v[158:159], v[152:153]
    v_max3_f32 v28, v22, v23, v28
    s_waitcnt lgkmcnt(1)
    v_pk_fma_f32 v[164:165], v[154:155], v[112:113], v[164:165]
    v_pk_fma_f32 v[166:167], v[158:159], v[112:113], v[166:167]
    s_sub_u32 s69, s69, 1
    s_cmp_lg_u32 s69, 1
    ds_write2_b32 v12, v164, v166 offset0:64 offset1:96
    ds_write2_b32 v13, v165, v167 offset0:64 offset1:96
    s_cbranch_scc1 L_loop
L_final:
    s_setprio 1
    s_lshl_b32 s88, s63, 2
    v_mov_b32 v42, s88
    s_add_u32 s88, s63, 1
    s_cmp_eq_u32 s63, 11
    s_cselect_b32 s88, 0, s88
    s_mul_i32 s88, s88, 528
    v_add_u32 v43, 51744, v8
    ds_write_b32 v42, v46 offset:512
    s_mov_b32 exec_lo, 0
    v_add_u32 v43, s88, v43
    s_mov_b64 exec, -1
    ds_read_b64_tr_b16 v[18:19], v10 offset:128
    s_waitcnt lgkmcnt(4)
    v_mfma_f32_32x32x8_bf16 v[96:111], v[16:17], v[20:21], v[48:63]
    v_lshl_add_u64 v[12:13], v[36:37], 0, v[8:9]
    v_exp_f32 v112, v80
    v_exp_f32 v113, v81
    v_exp_f32 v114, v82
    v_exp_f32 v115, v83
    v_exp_f32 v116, v84
    v_exp_f32 v117, v85
    v_exp_f32 v118, v86
    v_exp_f32 v119, v87
    v_exp_f32 v120, v88
    v_exp_f32 v121, v89
    v_exp_f32 v122, v90
    v_exp_f32 v123, v91
    v_exp_f32 v124, v92
    v_exp_f32 v125, v93
    v_exp_f32 v126, v94
    v_exp_f32 v127, v95
    v_pk_add_f32 v[144:145], v[112:113], s[78:79]
    v_pk_fma_f32 v[146:147], v[80:81], v[114:115], v[80:81]
    v_pk_fma_f32 v[146:147], v[82:83], v[144:145], v[146:147]
    v_pk_fma_f32 v[144:145], v[144:145], v[114:115], v[144:145]
    ds_read_b32 v24, v42 offset:516
    v_pk_fma_f32 v[146:147], v[146:147], v[116:117], v[146:147]
    v_pk_fma_f32 v[146:147], v[84:85], v[144:145], v[146:147]
    v_pk_fma_f32 v[144:145], v[144:145], v[116:117], v[144:145]
    v_pk_fma_f32 v[146:147], v[146:147], v[118:119], v[146:147]
    v_pk_fma_f32 v[146:147], v[86:87], v[144:145], v[146:147]
    v_pk_fma_f32 v[144:145], v[144:145], v[118:119], v[144:145]
    v_pk_fma_f32 v[146:147], v[146:147], v[120:121], v[146:147]
    v_pk_fma_f32 v[146:147], v[88:89], v[144:145], v[146:147]
    v_pk_fma_f32 v[144:145], v[144:145], v[120:121], v[144:145]
    v_pk_fma_f32 v[146:147], v[146:147], v[122:123], v[146:147]
    v_pk_fma_f32 v[146:147], v[90:91], v[144:145], v[146:147]
    v_pk_fma_f32 v[144:145], v[144:145], v[122:123], v[144:145]
    v_pk_fma_f32 v[146:147], v[146:147], v[124:125], v[146:147]
    v_pk_fma_f32 v[146:147], v[92:93], v[144:145], v[146:147]
    v_pk_fma_f32 v[144:145], v[144:145], v[124:125], v[144:145]
    v_pk_fma_f32 v[146:147], v[146:147], v[126:127], v[146:147]
    v_pk_fma_f32 v[146:147], v[94:95], v[144:145], v[146:147]
    v_pk_fma_f32 v[144:145], v[144:145], v[126:127], v[144:145]
    s_cmp_eq_u32 s69, s64
    s_cbranch_scc1 L_ownf
L_ownf_ret:
    s_waitcnt lgkmcnt(0)
    v_cmp_eq_u32 vcc, 0, v24
    s_cbranch_vccnz L_cw
L_cw_ret:
    ds_read2_b32 v[26:27], v43 offset0:0 offset1:32
    ds_read_b32 v160, v12 offset:0
    ds_read_b32 v161, v13 offset:0
    ds_read_b32 v162, v12 offset:128
    ds_read_b32 v163, v13 offset:128
    ds_read_b64_tr_b16 v[20:21], v10 offset:192
    s_waitcnt vmcnt(0)
    s_cmp_ge_u32 s63, 7
    s_cbranch_scc1 L_nw2a
    v_lshlrev_b32 v40, 4, v1
    v_and_b32 v41, 0xf0, v40
    s_mov_b32 s88, 622592
    buffer_load_dwordx4 v[128:131], v40, s[4:7], s88 offen offset:0 sc1
    buffer_load_dwordx4 v[132:135], v40, s[4:7], s88 offen offset:1024 sc1
    buffer_load_dwordx4 v[136:139], v40, s[4:7], s88 offen offset:2048 sc1
    buffer_load_dwordx4 v[140:143], v40, s[4:7], s88 offen offset:3072 sc1
    s_mov_b32 s88, 626688
    buffer_load_dwordx4 v[48:51], v40, s[4:7], s88 offen offset:0 sc1
    buffer_load_dwordx4 v[52:55], v40, s[4:7], s88 offen offset:1024 sc1
    buffer_load_dwordx4 v[56:59], v40, s[4:7], s88 offen offset:2048 sc1
    buffer_load_dwordx4 v[60:63], v40, s[4:7], s88 offen offset:3072 sc1
    s_mov_b32 s88, 638976
    buffer_load_dwordx4 v[2:5], v41, s[4:7], s88 offen sc1
L_nw2a:
    v_lshlrev_b64 v[80:81], 16, v[64:65]
    v_lshlrev_b64 v[82:83], 16, v[66:67]
    v_lshlrev_b64 v[84:85], 16, v[68:69]
    v_lshlrev_b64 v[86:87], 16, v[70:71]
    v_lshlrev_b64 v[88:89], 16, v[72:73]
    v_lshlrev_b64 v[90:91], 16, v[74:75]
    v_lshlrev_b64 v[92:93], 16, v[76:77]
    v_lshlrev_b64 v[94:95], 16, v[78:79]
    v_exp_f32 v112, v96
    v_exp_f32 v113, v97
    v_mfma_f32_32x32x8_bf16 v[80:95], v[16:17], v[18:19], v[80:95]
    v_exp_f32 v114, v98
    v_exp_f32 v115, v99
    v_exp_f32 v116, v100
    v_exp_f32 v117, v101
    v_exp_f32 v118, v102
    v_exp_f32 v119, v103
    v_exp_f32 v120, v104
    v_exp_f32 v121, v105
    v_exp_f32 v122, v106
    v_exp_f32 v123, v107
    v_exp_f32 v124, v108
    v_exp_f32 v125, v109
    v_exp_f32 v126, v110
    v_exp_f32 v127, v111
    v_pk_add_f32 v[148:149], v[112:113], s[78:79]
    v_pk_fma_f32 v[150:151], v[96:97], v[114:115], v[96:97]
    v_pk_fma_f32 v[150:151], v[98:99], v[148:149], v[150:151]
    v_pk_fma_f32 v[148:149], v[148:149], v[114:115], v[148:149]
    v_pk_fma_f32 v[150:151], v[150:151], v[116:117], v[150:151]
    v_pk_fma_f32 v[150:151], v[100:101], v[148:149], v[150:151]
    v_pk_fma_f32 v[148:149], v[148:149], v[116:117], v[148:149]
    v_pk_fma_f32 v[150:151], v[150:151], v[118:119], v[150:151]
    v_pk_fma_f32 v[150:151], v[102:103], v[148:149], v[150:151]
    v_pk_fma_f32 v[148:149], v[148:149], v[118:119], v[148:149]
    v_pk_fma_f32 v[150:151], v[150:151], v[120:121], v[150:151]
    v_pk_fma_f32 v[150:151], v[104:105], v[148:149], v[150:151]
    v_pk_fma_f32 v[148:149], v[148:149], v[120:121], v[148:149]
    v_pk_fma_f32 v[150:151], v[150:151], v[122:123], v[150:151]
    v_pk_fma_f32 v[150:151], v[106:107], v[148:149], v[150:151]
    v_pk_fma_f32 v[148:149], v[148:149], v[122:123], v[148:149]
    v_pk_fma_f32 v[150:151], v[150:151], v[124:125], v[150:151]
    v_pk_fma_f32 v[150:151], v[108:109], v[148:149], v[150:151]
    v_pk_fma_f32 v[148:149], v[148:149], v[124:125], v[148:149]
    v_pk_fma_f32 v[150:151], v[150:151], v[126:127], v[150:151]
    v_pk_fma_f32 v[150:151], v[110:111], v[148:149], v[150:151]
    v_pk_fma_f32 v[148:149], v[148:149], v[126:127], v[148:149]
    v_pk_mul_f32 v[22:23], v[144:145], v[148:149]
    v_rcp_f32 v112, v22
    v_rcp_f32 v113, v23
    v_pk_mul_f32 v[146:147], v[146:147], v[148:149]
    v_pk_mul_f32 v[150:151], v[150:151], v[144:145]
    v_max3_f32 v28, v22, v23, v28
    s_waitcnt lgkmcnt(1)
    v_add_f32 v161, v161, v26
    v_add_f32 v163, v163, v27
    v_pk_fma_f32 v[160:161], v[146:147], v[112:113], v[160:161]
    v_pk_fma_f32 v[162:163], v[150:151], v[112:113], v[162:163]
    ds_write2_b32 v12, v160, v162 offset0:0 offset1:32
    ds_write2_b32 v13, v161, v163 offset0:0 offset1:32
    s_waitcnt lgkmcnt(2)
    v_mfma_f32_32x32x8_bf16 v[96:111], v[16:17], v[20:21], v[64:79]
    v_exp_f32 v112, v80
    v_exp_f32 v113, v81
    v_exp_f32 v114, v82
    v_exp_f32 v115, v83
    v_exp_f32 v116, v84
    v_exp_f32 v117, v85
    v_exp_f32 v118, v86
    v_exp_f32 v119, v87
    v_exp_f32 v120, v88
    v_exp_f32 v121, v89
    v_exp_f32 v122, v90
    v_exp_f32 v123, v91
    v_exp_f32 v124, v92
    v_exp_f32 v125, v93
    v_exp_f32 v126, v94
    v_exp_f32 v127, v95
    v_pk_add_f32 v[152:153], v[112:113], s[78:79]
    v_pk_fma_f32 v[154:155], v[80:81], v[114:115], v[80:81]
    v_pk_fma_f32 v[154:155], v[82:83], v[152:153], v[154:155]
    v_pk_fma_f32 v[152:153], v[152:153], v[114:115], v[152:153]
    v_pk_fma_f32 v[154:155], v[154:155], v[116:117], v[154:155]
    v_pk_fma_f32 v[154:155], v[84:85], v[152:153], v[154:155]
    v_pk_fma_f32 v[152:153], v[152:153], v[116:117], v[152:153]
    v_pk_fma_f32 v[154:155], v[154:155], v[118:119], v[154:155]
    v_pk_fma_f32 v[154:155], v[86:87], v[152:153], v[154:155]
    v_pk_fma_f32 v[152:153], v[152:153], v[118:119], v[152:153]
    v_pk_fma_f32 v[154:155], v[154:155], v[120:121], v[154:155]
    v_pk_fma_f32 v[154:155], v[88:89], v[152:153], v[154:155]
    v_pk_fma_f32 v[152:153], v[152:153], v[120:121], v[152:153]
    v_pk_fma_f32 v[154:155], v[154:155], v[122:123], v[154:155]
    v_pk_fma_f32 v[154:155], v[90:91], v[152:153], v[154:155]
    v_pk_fma_f32 v[152:153], v[152:153], v[122:123], v[152:153]
    v_pk_fma_f32 v[154:155], v[154:155], v[124:125], v[154:155]
    v_pk_fma_f32 v[154:155], v[92:93], v[152:153], v[154:155]
    v_pk_fma_f32 v[152:153], v[152:153], v[124:125], v[152:153]
    v_pk_fma_f32 v[154:155], v[154:155], v[126:127], v[154:155]
    v_pk_fma_f32 v[154:155], v[94:95], v[152:153], v[154:155]
    v_pk_fma_f32 v[152:153], v[152:153], v[126:127], v[152:153]
    s_setprio 0
    ds_read2_b32 v[26:27], v43 offset0:64 offset1:96
    ds_read_b32 v164, v12 offset:256
    ds_read_b32 v165, v13 offset:256
    ds_read_b32 v166, v12 offset:384
    ds_read_b32 v167, v13 offset:384
    s_cmp_ge_u32 s63, 7
    s_cbranch_scc1 L_nw2b
    s_mov_b32 s88, 630784
    buffer_load_dwordx4 v[64:67], v40, s[4:7], s88 offen offset:0 sc1
    buffer_load_dwordx4 v[68:71], v40, s[4:7], s88 offen offset:1024 sc1
    buffer_load_dwordx4 v[72:75], v40, s[4:7], s88 offen offset:2048 sc1
    buffer_load_dwordx4 v[76:79], v40, s[4:7], s88 offen offset:3072 sc1
    s_mov_b32 s88, 634880
    buffer_load_dwordx4 v[80:83], v40, s[4:7], s88 offen offset:0 sc1
    buffer_load_dwordx4 v[84:87], v40, s[4:7], s88 offen offset:1024 sc1
    buffer_load_dwordx4 v[88:91], v40, s[4:7], s88 offen offset:2048 sc1
    buffer_load_dwordx4 v[92:95], v40, s[4:7], s88 offen offset:3072 sc1
L_nw2b:
    v_exp_f32 v112, v96
    v_exp_f32 v113, v97
    v_exp_f32 v114, v98
    v_exp_f32 v115, v99
    v_exp_f32 v116, v100
    v_exp_f32 v117, v101
    v_exp_f32 v118, v102
    v_exp_f32 v119, v103
    v_exp_f32 v120, v104
    v_exp_f32 v121, v105
    v_exp_f32 v122, v106
    v_exp_f32 v123, v107
    v_exp_f32 v124, v108
    v_exp_f32 v125, v109
    v_exp_f32 v126, v110
    v_exp_f32 v127, v111
    v_pk_add_f32 v[156:157], v[112:113], s[78:79]
    v_pk_fma_f32 v[158:159], v[96:97], v[114:115], v[96:97]
    v_pk_fma_f32 v[158:159], v[98:99], v[156:157], v[158:159]
    v_pk_fma_f32 v[156:157], v[156:157], v[114:115], v[156:157]
    v_pk_fma_f32 v[158:159], v[158:159], v[116:117], v[158:159]
    v_pk_fma_f32 v[158:159], v[100:101], v[156:157], v[158:159]
    v_pk_fma_f32 v[156:157], v[156:157], v[116:117], v[156:157]
    v_pk_fma_f32 v[158:159], v[158:159], v[118:119], v[158:159]
    v_pk_fma_f32 v[158:159], v[102:103], v[156:157], v[158:159]
    v_pk_fma_f32 v[156:157], v[156:157], v[118:119], v[156:157]
    v_pk_fma_f32 v[158:159], v[158:159], v[120:121], v[158:159]
    v_pk_fma_f32 v[158:159], v[104:105], v[156:157], v[158:159]
    v_pk_fma_f32 v[156:157], v[156:157], v[120:121], v[156:157]
    v_pk_fma_f32 v[158:159], v[158:159], v[122:123], v[158:159]
    v_pk_fma_f32 v[158:159], v[106:107], v[156:157], v[158:159]
    v_pk_fma_f32 v[156:157], v[156:157], v[122:123], v[156:157]
    v_pk_fma_f32 v[158:159], v[158:159], v[124:125], v[158:159]
    v_pk_fma_f32 v[158:159], v[108:109], v[156:157], v[158:159]
    v_pk_fma_f32 v[156:157], v[156:157], v[124:125], v[156:157]
    v_pk_fma_f32 v[158:159], v[158:159], v[126:127], v[158:159]
    v_pk_fma_f32 v[158:159], v[110:111], v[156:157], v[158:159]
    v_pk_fma_f32 v[156:157], v[156:157], v[126:127], v[156:157]
    v_pk_mul_f32 v[22:23], v[152:153], v[156:157]
    v_rcp_f32 v112, v22
    v_rcp_f32 v113, v23
    v_pk_mul_f32 v[154:155], v[154:155], v[156:157]
    v_pk_mul_f32 v[158:159], v[158:159], v[152:153]
    v_max3_f32 v28, v22, v23, v28
    s_waitcnt lgkmcnt(0)
    v_add_f32 v165, v165, v26
    v_add_f32 v167, v167, v27
    v_pk_fma_f32 v[164:165], v[154:155], v[112:113], v[164:165]
    v_pk_fma_f32 v[166:167], v[158:159], v[112:113], v[166:167]
    ds_write2_b32 v12, v164, v166 offset0:64 offset1:96
    ds_write2_b32 v13, v165, v167 offset0:64 offset1:96
    s_cmp_ge_u32 s63, 7
    s_cbranch_scc1 L_epi_wait
    s_branch L_epi2
L_loop_done:
    s_lshl_b32 s88, s63, 2
    v_mov_b32 v42, s88
    ds_write_b32 v42, v46 offset:512
L_epi:
    s_cmp_ge_u32 s63, 7
    s_cbranch_scc1 L_epi_wait
    s_waitcnt vmcnt(0)
    v_lshlrev_b32 v40, 4, v1
    v_and_b32 v41, 0xf0, v40
    s_mov_b32 s88, 622592
    buffer_load_dwordx4 v[128:131], v40, s[4:7], s88 offen offset:0 sc1
    buffer_load_dwordx4 v[132:135], v40, s[4:7], s88 offen offset:1024 sc1
    buffer_load_dwordx4 v[136:139], v40, s[4:7], s88 offen offset:2048 sc1
    buffer_load_dwordx4 v[140:143], v40, s[4:7], s88 offen offset:3072 sc1
    s_mov_b32 s88, 626688
    buffer_load_dwordx4 v[48:51], v40, s[4:7], s88 offen offset:0 sc1
    buffer_load_dwordx4 v[52:55], v40, s[4:7], s88 offen offset:1024 sc1
    buffer_load_dwordx4 v[56:59], v40, s[4:7], s88 offen offset:2048 sc1
    buffer_load_dwordx4 v[60:63], v40, s[4:7], s88 offen offset:3072 sc1
    s_mov_b32 s88, 638976
    buffer_load_dwordx4 v[2:5], v41, s[4:7], s88 offen sc1
    s_mov_b32 s88, 630784
    buffer_load_dwordx4 v[64:67], v40, s[4:7], s88 offen offset:0 sc1
    buffer_load_dwordx4 v[68:71], v40, s[4:7], s88 offen offset:1024 sc1
    buffer_load_dwordx4 v[72:75], v40, s[4:7], s88 offen offset:2048 sc1
    buffer_load_dwordx4 v[76:79], v40, s[4:7], s88 offen offset:3072 sc1
    s_mov_b32 s88, 634880
    buffer_load_dwordx4 v[80:83], v40, s[4:7], s88 offen offset:0 sc1
    buffer_load_dwordx4 v[84:87], v40, s[4:7], s88 offen offset:1024 sc1
    buffer_load_dwordx4 v[88:91], v40, s[4:7], s88 offen offset:2048 sc1
    buffer_load_dwordx4 v[92:95], v40, s[4:7], s88 offen offset:3072 sc1
L_epi2:
    v_and_b32 v42, 15, v1
    s_lshl_b32 s88, s63, 4
    v_add_u32 v43, s88, v42
    v_min_u32 v43, 98, v43
    v_lshrrev_b32 v47, 4, v1
    v_lshl_add_u32 v45, v47, 2, s88
    v_lshlrev_b32 v47, 2, v45
    ds_read_b128 v[32:35], v47 offset:0
    v_bfe_u32 v46, v1, 4, 1
    v_lshrrev_b32 v47, 5, v1
    v_lshlrev_b32 v46, 8, v46
    v_lshl_add_u32 v46, v47, 7, v46
    v_add_u32 v46, 76032, v46
    v_mul_u32_u24 v43, 528, v43
    v_add_u32 v43, v43, v46
    v_lshlrev_b32 v45, 7, v45
    v_lshl_add_u32 v45, v42, 3, v45
    s_mov_b32 s88, 3207688728
    s_waitcnt vmcnt(8) lgkmcnt(0)
    v_cvt_f32_u32 v32, v32
    v_cvt_f32_u32 v33, v33
    v_cvt_f32_u32 v34, v34
    v_cvt_f32_u32 v35, v35
    v_pk_mul_f32 v[12:13], v[32:33], v[2:3] op_sel:[0,0] op_sel_hi:[1,0]
    v_pk_mul_f32 v[14:15], v[34:35], v[2:3] op_sel:[0,0] op_sel_hi:[1,0]
    v_pk_mul_f32 v[16:17], v[32:33], v[2:3] op_sel:[0,1] op_sel_hi:[1,1]
    v_pk_mul_f32 v[18:19], v[34:35], v[2:3] op_sel:[0,1] op_sel_hi:[1,1]
    v_pk_mul_f32 v[20:21], v[32:33], v[4:5] op_sel:[0,0] op_sel_hi:[1,0]
    v_pk_mul_f32 v[22:23], v[34:35], v[4:5] op_sel:[0,0] op_sel_hi:[1,0]
    v_pk_mul_f32 v[24:25], v[32:33], v[4:5] op_sel:[0,1] op_sel_hi:[1,1]
    v_pk_mul_f32 v[26:27], v[34:35], v[4:5] op_sel:[0,1] op_sel_hi:[1,1]
L_epi_wait:
    s_xor_b32 s89, s63, 11
    s_xor_b32 s90, s2, 255
    s_or_b32 s89, s89, s90
    s_cmp_lg_u32 s89, 0
    s_cbranch_scc1 L_nogen
    v_mov_b32 v46, 0
    v_mov_b32 v47, s72
    s_mov_b64 exec, 1
    buffer_store_dword v47, v46, s[4:7], 0 offen sc0 sc1
    s_mov_b64 exec, -1
L_nogen:
    s_setprio 0
    v_cmp_nge_f32 vcc, 1904214016, v28
    s_waitcnt lgkmcnt(0)
    s_barrier
    s_cmp_ge_u32 s63, 7
    s_cbranch_scc1 L_epi_end
    ds_read_b128 v[96:99], v43 offset:0
    ds_read_b128 v[100:103], v43 offset:16
    ds_read_b128 v[104:107], v43 offset:32
    ds_read_b128 v[108:111], v43 offset:48
    ds_read_b128 v[112:115], v43 offset:64
    ds_read_b128 v[116:119], v43 offset:80
    ds_read_b128 v[120:123], v43 offset:96
    ds_read_b128 v[124:127], v43 offset:112
    s_waitcnt vmcnt(0)
    s_waitcnt lgkmcnt(6)
    v_cvt_pk_bf16_f32 v96, v96, v97
    v_cvt_pk_bf16_f32 v97, v98, v99
    v_cvt_pk_bf16_f32 v98, v100, v101
    v_cvt_pk_bf16_f32 v99, v102, v103
    s_waitcnt lgkmcnt(4)
    v_cvt_pk_bf16_f32 v104, v104, v105
    v_mfma_f32_16x16x32_bf16 v[12:15], v[96:99], v[128:131], v[12:15]
    v_cvt_pk_bf16_f32 v105, v106, v107
    v_mfma_f32_16x16x32_bf16 v[16:19], v[96:99], v[48:51], v[16:19]
    v_cvt_pk_bf16_f32 v106, v108, v109
    v_mfma_f32_16x16x32_bf16 v[20:23], v[96:99], v[64:67], v[20:23]
    v_cvt_pk_bf16_f32 v107, v110, v111
    v_mfma_f32_16x16x32_bf16 v[24:27], v[96:99], v[80:83], v[24:27]
    s_waitcnt lgkmcnt(2)
    v_cvt_pk_bf16_f32 v112, v112, v113
    v_mfma_f32_16x16x32_bf16 v[12:15], v[104:107], v[132:135], v[12:15]
    v_cvt_pk_bf16_f32 v113, v114, v115
    v_mfma_f32_16x16x32_bf16 v[16:19], v[104:107], v[52:55], v[16:19]
    v_cvt_pk_bf16_f32 v114, v116, v117
    v_mfma_f32_16x16x32_bf16 v[20:23], v[104:107], v[68:71], v[20:23]
    v_cvt_pk_bf16_f32 v115, v118, v119
    v_mfma_f32_16x16x32_bf16 v[24:27], v[104:107], v[84:87], v[24:27]
    s_waitcnt lgkmcnt(0)
    v_cvt_pk_bf16_f32 v120, v120, v121
    v_mfma_f32_16x16x32_bf16 v[12:15], v[112:115], v[136:139], v[12:15]
    v_cvt_pk_bf16_f32 v121, v122, v123
    v_mfma_f32_16x16x32_bf16 v[16:19], v[112:115], v[56:59], v[16:19]
    v_cvt_pk_bf16_f32 v122, v124, v125
    v_mfma_f32_16x16x32_bf16 v[20:23], v[112:115], v[72:75], v[20:23]
    v_cvt_pk_bf16_f32 v123, v126, v127
    v_mfma_f32_16x16x32_bf16 v[24:27], v[112:115], v[88:91], v[24:27]
    s_nop 0
    v_mfma_f32_16x16x32_bf16 v[12:15], v[120:123], v[140:143], v[12:15]
    v_mfma_f32_16x16x32_bf16 v[16:19], v[120:123], v[60:63], v[16:19]
    v_mfma_f32_16x16x32_bf16 v[20:23], v[120:123], v[76:79], v[20:23]
    v_mfma_f32_16x16x32_bf16 v[24:27], v[120:123], v[92:95], v[24:27]
    s_mov_b32 s89, s88
    s_nop 6
    v_mul_f32 v12, s88, v12
    v_mul_f32 v13, s88, v13
    v_mul_f32 v14, s88, v14
    v_mul_f32 v15, s88, v15
    v_mul_f32 v16, s88, v16
    v_mul_f32 v17, s88, v17
    v_mul_f32 v18, s88, v18
    v_mul_f32 v19, s88, v19
    v_mul_f32 v20, s88, v20
    v_mul_f32 v21, s88, v21
    v_mul_f32 v22, s88, v22
    v_mul_f32 v23, s88, v23
    v_mul_f32 v24, s88, v24
    v_mul_f32 v25, s88, v25
    v_mul_f32 v26, s88, v26
    v_mul_f32 v27, s88, v27
    v_cvt_pk_bf16_f32 v144, v12, v16
    v_cvt_pk_bf16_f32 v145, v20, v24
    buffer_store_dwordx2 v[144:145], v45, s[12:15], 0 offen offset:0 sc1
    v_cvt_pk_bf16_f32 v146, v13, v17
    v_cvt_pk_bf16_f32 v147, v21, v25
    buffer_store_dwordx2 v[146:147], v45, s[12:15], 0 offen offset:128 sc1
    v_cvt_pk_bf16_f32 v148, v14, v18
    v_cvt_pk_bf16_f32 v149, v22, v26
    buffer_store_dwordx2 v[148:149], v45, s[12:15], 0 offen offset:256 sc1
    v_cvt_pk_bf16_f32 v150, v15, v19
    v_cvt_pk_bf16_f32 v151, v23, v27
    buffer_store_dwordx2 v[150:151], v45, s[12:15], 0 offen offset:384 sc1
    v_add_f32 v72, v12, v13
    v_add_f32 v73, v14, v15
    v_add_f32 v72, v72, v73
    v_mov_b32 v73, 0x7f800000
    v_cmp_nlt_f32 s[84:85], |v72|, v73
    s_or_b64 vcc, vcc, s[84:85]
L_epi_end:
    s_cmp_lg_u32 s75, 0
    s_cbranch_scc1 L_fin
    v_mov_b32 v72, 0
    v_mov_b32 v73, 1
    s_cmp_eq_u64 vcc, 0
    s_cbranch_scc1 L_noflag
    ds_write_b32 v72, v73 offset:1040
L_noflag:
    s_waitcnt lgkmcnt(0)
    s_barrier
    ds_read_b32 v73, v72 offset:1040
    s_waitcnt lgkmcnt(0)
    v_readfirstlane_b32 s71, v73
    s_cmp_lg_u32 s71, 0
    s_cbranch_scc1 L_slow
L_fin:
L_exit:
    s_endpgm
L_prio2:
    s_cmp_eq_u32 s69, 3
    s_cbranch_scc0 L_prio2_0
    s_setprio 2
L_prio2_0:
    s_branch L_prio2_ret
L_own:
    s_mov_b32 s88, 0
L_own_l:
    ds_read_b32 v45, v47 offset:1024
    s_waitcnt lgkmcnt(0)
    v_cmp_gt_u32 vcc, 12, v45
    s_cbranch_vccz L_own_ret
    s_add_u32 s88, s88, 1
    s_cmp_gt_u32 s88, 0x100000
    s_cbranch_scc1 L_exit
    s_sleep 1
    s_branch L_own_l
L_ownf:
    s_mov_b32 s88, 0
L_ownf_l:
    ds_read_b32 v45, v47 offset:1024
    s_waitcnt lgkmcnt(0)
    v_cmp_gt_u32 vcc, 12, v45
    s_cbranch_vccz L_ownf_ret
    s_add_u32 s88, s88, 1
    s_cmp_gt_u32 s88, 0x100000
    s_cbranch_scc1 L_exit
    s_sleep 1
    s_branch L_ownf_l
L_build2:
    s_waitcnt lgkmcnt(0)
    v_add_u32 v144, 192, v144
    v_add_u32 v145, 384, v145
    s_cmp_lt_u32 s30, 7
    s_cbranch_scc1 L_build
    s_lshl_b32 s88, s30, 5
    s_add_u32 s89, s88, 75104
    v_mov_b32 v144, s89
    s_add_u32 s89, s89, s88
    v_mov_b32 v145, s89
    s_branch L_build
L_cw:
    s_cmp_eq_u32 s63, 11
    s_cbranch_scc1 L_cw_ret
    s_mov_b32 s88, 0
L_cw_l:
    ds_read_b32 v24, v42 offset:516
    s_waitcnt lgkmcnt(0)
    v_cmp_eq_u32 vcc, 0, v24
    s_cbranch_vccz L_cw_ret
    s_add_u32 s88, s88, 1
    s_cmp_gt_u32 s88, 0x100000
    s_cbranch_scc1 L_exit
    s_sleep 1
    s_branch L_cw_l
L_fx8:
    v_min_u32 v142, 79, v51
    v_subrev_u32 v142, 56, v142
    v_mov_b32 v143, 75328
    v_lshl_add_u32 v136, v142, 2, v143
    v_lshl_add_u32 v142, v142, 3, v143
    v_cndmask_b32 v141, v141, v136, vcc
    v_cndmask_b32 v108, v108, v142, vcc
    s_branch L_fr8
L_fx9:
    v_min_u32 v142, 79, v55
    v_subrev_u32 v142, 56, v142
    v_mov_b32 v143, 75328
    v_lshl_add_u32 v136, v142, 2, v143
    v_lshl_add_u32 v142, v142, 3, v143
    v_cndmask_b32 v141, v141, v136, vcc
    v_cndmask_b32 v109, v109, v142, vcc
    s_branch L_fr9
L_fx10:
    v_min_u32 v142, 79, v59
    v_subrev_u32 v142, 56, v142
    v_mov_b32 v143, 75328
    v_lshl_add_u32 v136, v142, 2, v143
    v_lshl_add_u32 v142, v142, 3, v143
    v_cndmask_b32 v141, v141, v136, vcc
    v_cndmask_b32 v110, v110, v142, vcc
    s_branch L_fr10
L_fx11:
    v_min_u32 v142, 79, v63
    v_subrev_u32 v142, 56, v142
    v_mov_b32 v143, 75328
    v_lshl_add_u32 v136, v142, 2, v143
    v_lshl_add_u32 v142, v142, 3, v143
    v_cndmask_b32 v141, v141, v136, vcc
    v_cndmask_b32 v111, v111, v142, vcc
    s_branch L_fr11
L_fx12:
    v_min_u32 v142, 79, v67
    v_subrev_u32 v142, 56, v142
    v_mov_b32 v143, 75328
    v_lshl_add_u32 v136, v142, 2, v143
    v_lshl_add_u32 v142, v142, 3, v143
    v_cndmask_b32 v141, v141, v136, vcc
    v_cndmask_b32 v112, v112, v142, vcc
    s_branch L_fr12
L_fx14:
    v_min_u32 v142, 79, v71
    v_subrev_u32 v142, 56, v142
    v_mov_b32 v143, 75328
    v_lshl_add_u32 v136, v142, 2, v143
    v_lshl_add_u32 v142, v142, 3, v143
    v_cndmask_b32 v141, v141, v136, vcc
    v_cndmask_b32 v113, v113, v142, vcc
    s_branch L_fr14
L_fx15:
    v_min_u32 v142, 79, v75
    v_subrev_u32 v142, 56, v142
    v_mov_b32 v143, 75328
    v_lshl_add_u32 v136, v142, 2, v143
    v_lshl_add_u32 v142, v142, 3, v143
    v_cndmask_b32 v141, v141, v136, vcc
    v_cndmask_b32 v114, v114, v142, vcc
    s_branch L_fr15
L_fx16:
    v_min_u32 v142, 79, v79
    v_subrev_u32 v142, 56, v142
    v_mov_b32 v143, 75328
    v_lshl_add_u32 v136, v142, 2, v143
    v_lshl_add_u32 v142, v142, 3, v143
    v_cndmask_b32 v141, v141, v136, vcc
    v_cndmask_b32 v115, v115, v142, vcc
    s_branch L_fr16
L_fx17:
    v_min_u32 v142, 79, v83
    v_subrev_u32 v142, 56, v142
    v_mov_b32 v143, 75328
    v_lshl_add_u32 v136, v142, 2, v143
    v_lshl_add_u32 v142, v142, 3, v143
    v_cndmask_b32 v141, v141, v136, vcc
    v_cndmask_b32 v116, v116, v142, vcc
    s_branch L_fr17
L_fx18:
    v_min_u32 v142, 79, v87
    v_subrev_u32 v142, 56, v142
    v_mov_b32 v143, 75328
    v_lshl_add_u32 v136, v142, 2, v143
    v_lshl_add_u32 v142, v142, 3, v143
    v_cndmask_b32 v141, v141, v136, vcc
    v_cndmask_b32 v117, v117, v142, vcc
    s_branch L_fr18
L_fx20:
    v_min_u32 v142, 79, v91
    v_subrev_u32 v142, 56, v142
    v_mov_b32 v143, 75328
    v_lshl_add_u32 v136, v142, 2, v143
    v_lshl_add_u32 v142, v142, 3, v143
    v_cndmask_b32 v141, v141, v136, vcc
    v_cndmask_b32 v118, v118, v142, vcc
    s_branch L_fr20
L_fx21:
    v_min_u32 v142, 79, v95
    v_subrev_u32 v142, 56, v142
    v_mov_b32 v143, 75328
    v_lshl_add_u32 v136, v142, 2, v143
    v_lshl_add_u32 v142, v142, 3, v143
    v_cndmask_b32 v141, v141, v136, vcc
    v_cndmask_b32 v119, v119, v142, vcc
    s_branch L_fr21
L_fx22:
    v_min_u32 v142, 79, v99
    v_subrev_u32 v142, 56, v142
    v_mov_b32 v143, 75328
    v_lshl_add_u32 v136, v142, 2, v143
    v_lshl_add_u32 v142, v142, 3, v143
    v_cndmask_b32 v141, v141, v136, vcc
    v_cndmask_b32 v120, v120, v142, vcc
    s_branch L_fr22
L_fx23:
    v_min_u32 v142, 79, v103
    v_subrev_u32 v142, 56, v142
    v_mov_b32 v143, 75328
    v_lshl_add_u32 v136, v142, 2, v143
    v_lshl_add_u32 v142, v142, 3, v143
    v_cndmask_b32 v141, v141, v136, vcc
    v_cndmask_b32 v121, v121, v142, vcc
    s_branch L_fr23
L_fx24:
    v_min_u32 v142, 79, v107
    v_subrev_u32 v142, 56, v142
    v_mov_b32 v143, 75328
    v_lshl_add_u32 v136, v142, 2, v143
    v_lshl_add_u32 v142, v142, 3, v143
    v_cndmask_b32 v141, v141, v136, vcc
    v_cndmask_b32 v122, v122, v142, vcc
    s_branch L_fr24
L_w2ld:
    s_cmp_gt_u32 s2, 16
    s_cbranch_scc1 L_p_done
    s_cmp_lt_u32 s2, 16
    s_cbranch_scc1 L_opt_c
    v_lshlrev_b32 v12, 1, v1
    global_load_ushort v32, v12, s[46:47]
    s_branch L_p_done
L_opt_c:
    s_and_b32 s88, s2, 3
    s_lshl_b32 s88, s88, 10
    s_lshr_b32 s91, s2, 2
    s_lshl_b32 s91, s91, 1
    s_add_u32 s88, s88, s91
    v_bfe_u32 v12, v1, 4, 1
    v_lshlrev_b32 v12, 13, v12
    v_lshrrev_b32 v13, 5, v1
    v_lshl_add_u32 v12, v13, 12, v12
    v_and_b32 v13, 15, v1
    v_lshl_add_u32 v12, v13, 3, v12
    buffer_load_ushort v32, v12, s[28:31], s88 offen offset:0
    buffer_load_ushort v33, v12, s[28:31], s88 offen offset:128
    buffer_load_ushort v34, v12, s[28:31], s88 offen offset:256
    buffer_load_ushort v35, v12, s[28:31], s88 offen offset:384
    buffer_load_ushort v36, v12, s[28:31], s88 offen offset:512
    buffer_load_ushort v37, v12, s[28:31], s88 offen offset:640
    buffer_load_ushort v38, v12, s[28:31], s88 offen offset:768
    buffer_load_ushort v39, v12, s[28:31], s88 offen offset:896
    s_branch L_p_done
L_slow:
    s_setprio 0
    s_mov_b32 s75, 1
    s_mov_b32 s76, 0
    s_waitcnt vmcnt(0) lgkmcnt(0)
    s_barrier
    v_mov_b32 v46, 1
    v_mov_b32 v28, 0
    v_lshlrev_b32 v64, 2, v0
    v_mov_b32 v65, 0
    v_cmp_gt_u32 vcc, 272, v0
    s_and_b64 exec, exec, vcc
    ds_write_b32 v64, v65
    s_mov_b64 exec, -1
    v_mov_b32 v64, 0
    v_mov_b32 v65, 0
    v_mov_b32 v66, 0
    v_mov_b32 v67, 0
    v_lshlrev_b32 v68, 4, v0
    v_add_u32 v68, 76032, v68
    ds_write_b128 v68, v[64:67] offset:0
    ds_write_b128 v68, v[64:67] offset:12288
    ds_write_b128 v68, v[64:67] offset:24576
    ds_write_b128 v68, v[64:67] offset:36864
    v_cmp_gt_u32 vcc, 558, v0
    s_and_b64 exec, exec, vcc
    ds_write_b128 v68, v[64:67] offset:49152
    s_mov_b64 exec, -1
    v_lshrrev_b32 v141, 3, v1
    v_lshlrev_b32 v136, 11, v141
    v_and_b32 v138, 7, v1
    v_mul_u32_u24 v139, 12, v138
    s_mov_b32 s88, 37632
    v_mad_u32_u24 v139, v141, s88, v139
    s_lshl_b32 s65, s63, 14
    s_lshr_b32 s89, s62, 2
    s_lshl_b32 s89, s89, 4
    s_add_u32 s65, s65, s89
    s_and_b32 s89, s62, 1
    s_lshl_b32 s89, s89, 3
    s_add_u32 s65, s65, s89
    s_and_b32 s89, s62, 2
    s_lshl_b32 s89, s89, 9
    s_add_u32 s65, s65, s89
    s_add_u32 s65, s65, 65536
    s_add_u32 s66, s65, 196608
    s_add_u32 s67, s65, 393216
    s_mul_i32 s68, s63, 301056
    s_add_u32 s68, s68, 1048576
    buffer_load_dwordx2 v[124:125], v136, s[4:7], s65 offen sc1
    buffer_load_dwordx2 v[126:127], v136, s[4:7], s66 offen sc1
    buffer_load_dwordx2 v[128:129], v136, s[4:7], s67 offen sc1
    s_waitcnt vmcnt(0)
    s_cmp_lt_u32 s63, 8
    s_cselect_b32 s88, -1, 0
    v_and_b32 v128, s88, v128
    v_and_b32 v130, 0xfff, v124
    v_mad_u32_u24 v130, v130, 12, v139
    v_bfe_u32 v133, v124, 12, 12
    v_sub_u32 v133, v133, v138
    v_and_b32 v131, 0xfff, v126
    v_mad_u32_u24 v131, v131, 12, v139
    v_add_u32 v131, 3612672, v131
    v_bfe_u32 v134, v126, 12, 12
    v_sub_u32 v134, v134, v138
    v_and_b32 v132, 0xfff, v128
    v_mad_u32_u24 v132, v132, 12, v139
    v_add_u32 v132, 7225344, v132
    v_bfe_u32 v135, v128, 12, 12
    v_sub_u32 v135, v135, v138
    v_mov_b32 v144, v130
    v_mov_b32 v147, v133
    v_mov_b32 v145, v131
    v_mov_b32 v148, v134
    v_mov_b32 v146, v132
    v_mov_b32 v149, v135
    s_mov_b32 s93, 66585596
    v_mov_b32 v150, 1543527424
    v_mov_b32 v39, 0x3c00
    v_and_b32 v72, 31, v1
    v_lshlrev_b32 v72, 2, v72
    v_add_u32 v8, 76032, v72
    v_add_u32 v9, 76032, v72
    v_bfe_u32 v73, v1, 4, 1
    v_lshlrev_b32 v73, 5, v73
    v_and_b32 v74, 3, v1
    v_lshl_add_u32 v73, v74, 3, v73
    v_add_u32 v44, 134112, v73
    v_bfe_u32 v75, v1, 2, 2
    v_add_u32 v76, 98, v75
    v_mul_u32_u24 v76, 264, v76
    v_add_u32 v10, v76, v44
    v_max3_i32 v137, v147, v148, v149
    v_max_i32 v137, 0, v137
    v_mov_b32 v138, 0
    s_waitcnt lgkmcnt(0)
    s_barrier
    ds_max_u32 v138, v137 offset:1044
    s_waitcnt lgkmcnt(0)
    s_barrier
    ds_read_b32 v137, v138 offset:1044
    s_waitcnt lgkmcnt(0)
    v_readfirstlane_b32 s77, v137
L_round:
    s_barrier
    s_mov_b32 s88, 1561
    v_mul_u32_u24 v69, s88, v0
    v_lshrrev_b32 v69, 16, v69
    v_mul_u32_u24 v69, 42, v69
    v_sub_u32 v69, v0, v69
    v_cmp_gt_u32 vcc, 14, v69
    v_mov_b32 v70, 1609587712
    v_lshlrev_b32 v71, 4, v0
    v_cndmask_b32 v64, 0, v70, vcc
    v_add_u32 v68, 9472, v71
    v_mov_b32 v65, v64
    v_mov_b32 v66, v64
    v_mov_b32 v67, v64
    v_cmp_gt_u32 vcc, 756, v0
    s_and_b64 exec, exec, vcc
    ds_write_b128 v68, v[64:67] offset:0
    ds_write_b128 v68, v[64:67] offset:12096
    ds_write_b128 v68, v[64:67] offset:24192
    ds_write_b128 v68, v[64:67] offset:36288
    ds_write_b128 v68, v[64:67] offset:48384
    v_cmp_gt_u32 vcc, 378, v0
    s_and_b64 exec, exec, vcc
    ds_write_b128 v68, v[64:67] offset:60480
    s_mov_b64 exec, -1
    v_mov_b32 v72, 75520
    v_mov_b32 v73, 75936
    v_mov_b32 v74, 64
    v_mov_b32 v75, 1695599136
    v_cmp_gt_u32 vcc, 488, v0
    s_and_b64 exec, exec, vcc
    ds_write_b128 v71, v[72:75] offset:1600
    s_mov_b64 exec, -1
    v_lshlrev_b32 v64, 2, v0
    v_add_u32 v64, 161552, v64
    v_mov_b32 v65, 0
    v_cmp_gt_u32 vcc, 128, v0
    s_and_b64 exec, exec, vcc
    ds_write_b32 v64, v65
    s_mov_b64 exec, -1
    v_cmp_lt_i32 s[32:33], s76, v147
    v_cmp_lt_i32 s[34:35], s76, v148
    v_cmp_lt_i32 s[36:37], s76, v149
    s_mov_b64 exec, s[32:33]
    buffer_load_dwordx3 v[48:50], v144, s[4:7], s68 offen sc1
    s_mov_b64 exec, s[34:35]
    buffer_load_dwordx3 v[52:54], v145, s[4:7], s68 offen sc1
    s_mov_b64 exec, s[36:37]
    buffer_load_dwordx3 v[56:58], v146, s[4:7], s68 offen sc1
    s_mov_b64 exec, -1
    s_waitcnt vmcnt(0) lgkmcnt(0)
    s_barrier
    s_mov_b64 exec, s[32:33]
    v_bfe_u32 v60, v50, 10, 9
    v_and_or_b32 v50, v50, s93, v150
    v_add_u32 v72, 161040, v60
    ds_add_rtn_u32 v51, v72, v46 offset:512
    ds_add_u32 v60, v46 offset:0
    s_mov_b64 exec, s[34:35]
    v_bfe_u32 v61, v54, 10, 9
    v_and_or_b32 v54, v54, s93, v150
    v_add_u32 v73, 161040, v61
    ds_add_rtn_u32 v55, v73, v46 offset:512
    ds_add_u32 v61, v46 offset:0
    s_mov_b64 exec, s[36:37]
    v_bfe_u32 v62, v58, 10, 9
    v_and_or_b32 v58, v58, s93, v150
    v_add_u32 v74, 161040, v62
    ds_add_rtn_u32 v59, v74, v46 offset:512
    ds_add_u32 v62, v46 offset:0
    s_mov_b64 exec, -1
    s_waitcnt lgkmcnt(0)
    s_barrier
    v_lshlrev_b32 v64, 3, v1
    v_add_u32 v64, 161040, v64
    ds_read_b64 v[66:67], v64 offset:512
    s_waitcnt lgkmcnt(0)
    v_add_u32 v66, 7, v66
    v_add_u32 v67, 7, v67
    v_lshrrev_b32 v66, 3, v66
    v_lshrrev_b32 v67, 3, v67
    v_add_u32 v68, v66, v67
    v_mov_b32 v69, v68
    s_nop 1
    v_add_u32_dpp v69, v69, v69 row_shr:1 row_mask:0xf bank_mask:0xf bound_ctrl:0
    s_nop 1
    v_add_u32_dpp v69, v69, v69 row_shr:2 row_mask:0xf bank_mask:0xf bound_ctrl:0
    s_nop 1
    v_add_u32_dpp v69, v69, v69 row_shr:4 row_mask:0xf bank_mask:0xf bound_ctrl:0
    s_nop 1
    v_add_u32_dpp v69, v69, v69 row_shr:8 row_mask:0xf bank_mask:0xf bound_ctrl:0
    s_nop 1
    v_add_u32_dpp v69, v69, v69 row_bcast:15 row_mask:0xa bank_mask:0xf
    s_nop 1
    v_add_u32_dpp v69, v69, v69 row_bcast:31 row_mask:0xc bank_mask:0xf
    s_nop 1
    v_readlane_b32 s65, v69, 63
    v_sub_u32 v70, v69, v68
    v_add_u32 v71, v70, v66
    ds_write_b64 v64, v[70:71]
    s_add_u32 s3, s65, 3
    s_lshr_b32 s3, s3, 2
    s_waitcnt lgkmcnt(0)
    s_mov_b64 exec, s[32:33]
    ds_read_b32 v64, v72
    ds_read_b32 v71, v72 offset:512
    v_lshrrev_b32 v65, 3, v51
    v_and_b32 v66, 7, v51
    v_lshrrev_b32 v67, 2, v60
    s_waitcnt lgkmcnt(0)
    v_add_u32 v64, v64, v65
    v_lshlrev_b32 v65, 3, v65
    v_sub_u32 v71, v71, v65
    v_min_u32 v71, 8, v71
    v_lshlrev_b32 v71, 3, v71
    v_sub_u32 v71, 64, v71
    v_mul_u32_u24 v68, 528, v67
    v_mul_u32_u24 v69, 264, v67
    v_lshl_or_b32 v68, v69, 16, v68
    v_lshlrev_b32 v69, 4, v64
    v_add_u32 v69, 1600, v69
    ds_write2_b32 v69, v71, v68 offset0:2 offset1:3
    v_mul_u32_u24 v65, 9363, v64
    v_lshrrev_b32 v65, 16, v65
    v_mul_u32_u24 v67, 7, v65
    v_sub_u32 v64, v64, v67
    v_mul_u32_u24 v65, 672, v65
    v_add_u32 v65, 9472, v65
    v_lshl_add_u32 v67, v64, 5, v65
    v_lshl_add_u32 v70, v64, 6, v65
    v_add_u32 v70, 224, v70
    ds_write2_b32 v69, v67, v70 offset0:0 offset1:1
    v_lshl_add_u32 v75, v66, 2, v67
    v_lshl_add_u32 v76, v66, 3, v70
    ds_write_b32 v75, v50
    ds_write_b64 v76, v[48:49]
    s_waitcnt lgkmcnt(0)
    s_mov_b64 exec, s[34:35]
    ds_read_b32 v64, v73
    ds_read_b32 v71, v73 offset:512
    v_lshrrev_b32 v65, 3, v55
    v_and_b32 v66, 7, v55
    v_lshrrev_b32 v67, 2, v61
    s_waitcnt lgkmcnt(0)
    v_add_u32 v64, v64, v65
    v_lshlrev_b32 v65, 3, v65
    v_sub_u32 v71, v71, v65
    v_min_u32 v71, 8, v71
    v_lshlrev_b32 v71, 3, v71
    v_sub_u32 v71, 64, v71
    v_mul_u32_u24 v68, 528, v67
    v_mul_u32_u24 v69, 264, v67
    v_lshl_or_b32 v68, v69, 16, v68
    v_lshlrev_b32 v69, 4, v64
    v_add_u32 v69, 1600, v69
    ds_write2_b32 v69, v71, v68 offset0:2 offset1:3
    v_mul_u32_u24 v65, 9363, v64
    v_lshrrev_b32 v65, 16, v65
    v_mul_u32_u24 v67, 7, v65
    v_sub_u32 v64, v64, v67
    v_mul_u32_u24 v65, 672, v65
    v_add_u32 v65, 9472, v65
    v_lshl_add_u32 v67, v64, 5, v65
    v_lshl_add_u32 v70, v64, 6, v65
    v_add_u32 v70, 224, v70
    ds_write2_b32 v69, v67, v70 offset0:0 offset1:1
    v_lshl_add_u32 v75, v66, 2, v67
    v_lshl_add_u32 v76, v66, 3, v70
    ds_write_b32 v75, v54
    ds_write_b64 v76, v[52:53]
    s_waitcnt lgkmcnt(0)
    s_mov_b64 exec, s[36:37]
    ds_read_b32 v64, v74
    ds_read_b32 v71, v74 offset:512
    v_lshrrev_b32 v65, 3, v59
    v_and_b32 v66, 7, v59
    v_lshrrev_b32 v67, 2, v62
    s_waitcnt lgkmcnt(0)
    v_add_u32 v64, v64, v65
    v_lshlrev_b32 v65, 3, v65
    v_sub_u32 v71, v71, v65
    v_min_u32 v71, 8, v71
    v_lshlrev_b32 v71, 3, v71
    v_sub_u32 v71, 64, v71
    v_mul_u32_u24 v68, 528, v67
    v_mul_u32_u24 v69, 264, v67
    v_lshl_or_b32 v68, v69, 16, v68
    v_lshlrev_b32 v69, 4, v64
    v_add_u32 v69, 1600, v69
    ds_write2_b32 v69, v71, v68 offset0:2 offset1:3
    v_mul_u32_u24 v65, 9363, v64
    v_lshrrev_b32 v65, 16, v65
    v_mul_u32_u24 v67, 7, v65
    v_sub_u32 v64, v64, v67
    v_mul_u32_u24 v65, 672, v65
    v_add_u32 v65, 9472, v65
    v_lshl_add_u32 v67, v64, 5, v65
    v_lshl_add_u32 v70, v64, 6, v65
    v_add_u32 v70, 224, v70
    ds_write2_b32 v69, v67, v70 offset0:0 offset1:1
    v_lshl_add_u32 v75, v66, 2, v67
    v_lshl_add_u32 v76, v66, 3, v70
    ds_write_b32 v75, v58
    ds_write_b64 v76, v[56:57]
    s_waitcnt lgkmcnt(0)
    s_mov_b64 exec, -1
    s_barrier
    s_mov_b32 s69, s63
L_stile:
    s_cmp_ge_u32 s69, s3
    s_cbranch_scc1 L_stile_done
    s_lshl_b32 s88, s69, 6
    s_add_u32 s88, s88, 1600
    v_lshrrev_b32 v72, 5, v1
    v_bfe_u32 v74, v1, 2, 1
    v_and_b32 v75, 1, v1
    v_lshlrev_b32 v72, 1, v72
    v_lshl_add_u32 v74, v74, 1, v75
    v_add_u32 v73, 1, v72
    v_bfe_u32 v75, v1, 2, 2
    v_lshl_add_u32 v2, v72, 4, s88
    v_lshl_add_u32 v4, v74, 4, s88
    v_lshl_add_u32 v5, v75, 4, s88
    v_add_u32 v2, 12, v2
    v_lshl_add_u32 v4, v72, 1, v4
    v_add_u32 v5, 14, v5
    v_add_u32 v3, 16, v2
    ds_read2_b32 v[14:15], v4 offset0:1 offset1:0
    ds_read_u16 v11, v5
    ds_read_u16 v36, v2 offset:0
    ds_read_u16 v37, v3 offset:0
    s_waitcnt lgkmcnt(0)
    v_lshl_add_u64 v[14:15], v[14:15], 0, v[6:7]
    ds_read_b32 v38, v15
    ds_read_b64 v[16:17], v14
    s_waitcnt lgkmcnt(0)
    v_mfma_f32_32x32x8_f16 v[128:143], v[38:39], v[30:31], 0
    s_nop 15
    buffer_load_dword v48, v128, s[8:11], 0 offen offset:0 sc1
    buffer_load_dword v49, v129, s[8:11], 0 offen offset:0 sc1
    buffer_load_dword v50, v130, s[8:11], 0 offen offset:0 sc1
    buffer_load_dword v51, v131, s[8:11], 0 offen offset:0 sc1
    buffer_load_dword v52, v132, s[8:11], 0 offen offset:0 sc1
    buffer_load_dword v53, v133, s[8:11], 0 offen offset:0 sc1
    buffer_load_dword v54, v134, s[8:11], 0 offen offset:0 sc1
    buffer_load_dword v55, v135, s[8:11], 0 offen offset:0 sc1
    buffer_load_dword v56, v136, s[8:11], 0 offen offset:0 sc1
    buffer_load_dword v57, v137, s[8:11], 0 offen offset:0 sc1
    buffer_load_dword v58, v138, s[8:11], 0 offen offset:0 sc1
    buffer_load_dword v59, v139, s[8:11], 0 offen offset:0 sc1
    buffer_load_dword v60, v140, s[8:11], 0 offen offset:0 sc1
    buffer_load_dword v61, v141, s[8:11], 0 offen offset:0 sc1
    buffer_load_dword v62, v142, s[8:11], 0 offen offset:0 sc1
    buffer_load_dword v63, v143, s[8:11], 0 offen offset:0 sc1
    buffer_load_dword v64, v128, s[8:11], 0 offen offset:128 sc1
    buffer_load_dword v65, v129, s[8:11], 0 offen offset:128 sc1
    buffer_load_dword v66, v130, s[8:11], 0 offen offset:128 sc1
    buffer_load_dword v67, v131, s[8:11], 0 offen offset:128 sc1
    buffer_load_dword v68, v132, s[8:11], 0 offen offset:128 sc1
    buffer_load_dword v69, v133, s[8:11], 0 offen offset:128 sc1
    buffer_load_dword v70, v134, s[8:11], 0 offen offset:128 sc1
    buffer_load_dword v71, v135, s[8:11], 0 offen offset:128 sc1
    buffer_load_dword v72, v136, s[8:11], 0 offen offset:128 sc1
    buffer_load_dword v73, v137, s[8:11], 0 offen offset:128 sc1
    buffer_load_dword v74, v138, s[8:11], 0 offen offset:128 sc1
    buffer_load_dword v75, v139, s[8:11], 0 offen offset:128 sc1
    buffer_load_dword v76, v140, s[8:11], 0 offen offset:128 sc1
    buffer_load_dword v77, v141, s[8:11], 0 offen offset:128 sc1
    buffer_load_dword v78, v142, s[8:11], 0 offen offset:128 sc1
    buffer_load_dword v79, v143, s[8:11], 0 offen offset:128 sc1
    v_lshl_add_u64 v[12:13], v[36:37], 0, v[8:9]
    v_add_u32_dpp v10, v11, v44 quad_perm:[0,1,2,3] row_mask:0xc bank_mask:0xf
    s_waitcnt vmcnt(0)
    ds_read_b64_tr_b16 v[18:19], v10 offset:0
    ds_read_b64_tr_b16 v[20:21], v10 offset:64
    v_lshlrev_b64 v[80:81], 16, v[48:49]
    v_lshlrev_b64 v[82:83], 16, v[50:51]
    v_lshlrev_b64 v[84:85], 16, v[52:53]
    v_lshlrev_b64 v[86:87], 16, v[54:55]
    v_lshlrev_b64 v[88:89], 16, v[56:57]
    v_lshlrev_b64 v[90:91], 16, v[58:59]
    v_lshlrev_b64 v[92:93], 16, v[60:61]
    v_lshlrev_b64 v[94:95], 16, v[62:63]
    s_waitcnt lgkmcnt(0)
    s_nop 1
    v_mfma_f32_32x32x8_bf16 v[80:95], v[16:17], v[18:19], v[80:95]
    v_mfma_f32_32x32x8_bf16 v[96:111], v[16:17], v[20:21], v[48:63]
    s_nop 15
    v_exp_f32 v112, v80
    v_exp_f32 v113, v81
    v_exp_f32 v114, v82
    v_exp_f32 v115, v83
    v_exp_f32 v116, v84
    v_exp_f32 v117, v85
    v_exp_f32 v118, v86
    v_exp_f32 v119, v87
    v_exp_f32 v120, v88
    v_exp_f32 v121, v89
    v_exp_f32 v122, v90
    v_exp_f32 v123, v91
    v_exp_f32 v124, v92
    v_exp_f32 v125, v93
    v_exp_f32 v126, v94
    v_exp_f32 v127, v95
    v_add_f32 v112, 1.0, v112
    v_add_f32 v113, 1.0, v113
    v_add_f32 v114, 1.0, v114
    v_add_f32 v115, 1.0, v115
    v_add_f32 v116, 1.0, v116
    v_add_f32 v117, 1.0, v117
    v_add_f32 v118, 1.0, v118
    v_add_f32 v119, 1.0, v119
    v_add_f32 v120, 1.0, v120
    v_add_f32 v121, 1.0, v121
    v_add_f32 v122, 1.0, v122
    v_add_f32 v123, 1.0, v123
    v_add_f32 v124, 1.0, v124
    v_add_f32 v125, 1.0, v125
    v_add_f32 v126, 1.0, v126
    v_add_f32 v127, 1.0, v127
    v_rcp_f32 v112, v112
    v_rcp_f32 v113, v113
    v_rcp_f32 v114, v114
    v_rcp_f32 v115, v115
    v_rcp_f32 v116, v116
    v_rcp_f32 v117, v117
    v_rcp_f32 v118, v118
    v_rcp_f32 v119, v119
    v_rcp_f32 v120, v120
    v_rcp_f32 v121, v121
    v_rcp_f32 v122, v122
    v_rcp_f32 v123, v123
    v_rcp_f32 v124, v124
    v_rcp_f32 v125, v125
    v_rcp_f32 v126, v126
    v_rcp_f32 v127, v127
    v_pk_mul_f32 v[24:25], v[80:81], v[112:113]
    v_pk_fma_f32 v[24:25], v[82:83], v[114:115], v[24:25]
    v_pk_fma_f32 v[24:25], v[84:85], v[116:117], v[24:25]
    v_pk_fma_f32 v[24:25], v[86:87], v[118:119], v[24:25]
    v_pk_fma_f32 v[24:25], v[88:89], v[120:121], v[24:25]
    v_pk_fma_f32 v[24:25], v[90:91], v[122:123], v[24:25]
    v_pk_fma_f32 v[24:25], v[92:93], v[124:125], v[24:25]
    v_pk_fma_f32 v[24:25], v[94:95], v[126:127], v[24:25]
    ds_add_f32 v12, v24 offset:0
    ds_add_f32 v13, v25 offset:0
    s_waitcnt lgkmcnt(0)
    v_exp_f32 v112, v96
    v_exp_f32 v113, v97
    v_exp_f32 v114, v98
    v_exp_f32 v115, v99
    v_exp_f32 v116, v100
    v_exp_f32 v117, v101
    v_exp_f32 v118, v102
    v_exp_f32 v119, v103
    v_exp_f32 v120, v104
    v_exp_f32 v121, v105
    v_exp_f32 v122, v106
    v_exp_f32 v123, v107
    v_exp_f32 v124, v108
    v_exp_f32 v125, v109
    v_exp_f32 v126, v110
    v_exp_f32 v127, v111
    v_add_f32 v112, 1.0, v112
    v_add_f32 v113, 1.0, v113
    v_add_f32 v114, 1.0, v114
    v_add_f32 v115, 1.0, v115
    v_add_f32 v116, 1.0, v116
    v_add_f32 v117, 1.0, v117
    v_add_f32 v118, 1.0, v118
    v_add_f32 v119, 1.0, v119
    v_add_f32 v120, 1.0, v120
    v_add_f32 v121, 1.0, v121
    v_add_f32 v122, 1.0, v122
    v_add_f32 v123, 1.0, v123
    v_add_f32 v124, 1.0, v124
    v_add_f32 v125, 1.0, v125
    v_add_f32 v126, 1.0, v126
    v_add_f32 v127, 1.0, v127
    v_rcp_f32 v112, v112
    v_rcp_f32 v113, v113
    v_rcp_f32 v114, v114
    v_rcp_f32 v115, v115
    v_rcp_f32 v116, v116
    v_rcp_f32 v117, v117
    v_rcp_f32 v118, v118
    v_rcp_f32 v119, v119
    v_rcp_f32 v120, v120
    v_rcp_f32 v121, v121
    v_rcp_f32 v122, v122
    v_rcp_f32 v123, v123
    v_rcp_f32 v124, v124
    v_rcp_f32 v125, v125
    v_rcp_f32 v126, v126
    v_rcp_f32 v127, v127
    v_pk_mul_f32 v[24:25], v[96:97], v[112:113]
    v_pk_fma_f32 v[24:25], v[98:99], v[114:115], v[24:25]
    v_pk_fma_f32 v[24:25], v[100:101], v[116:117], v[24:25]
    v_pk_fma_f32 v[24:25], v[102:103], v[118:119], v[24:25]
    v_pk_fma_f32 v[24:25], v[104:105], v[120:121], v[24:25]
    v_pk_fma_f32 v[24:25], v[106:107], v[122:123], v[24:25]
    v_pk_fma_f32 v[24:25], v[108:109], v[124:125], v[24:25]
    v_pk_fma_f32 v[24:25], v[110:111], v[126:127], v[24:25]
    ds_add_f32 v12, v24 offset:128
    ds_add_f32 v13, v25 offset:128
    s_waitcnt lgkmcnt(0)
    ds_read_b64_tr_b16 v[18:19], v10 offset:128
    ds_read_b64_tr_b16 v[20:21], v10 offset:192
    v_lshlrev_b64 v[80:81], 16, v[64:65]
    v_lshlrev_b64 v[82:83], 16, v[66:67]
    v_lshlrev_b64 v[84:85], 16, v[68:69]
    v_lshlrev_b64 v[86:87], 16, v[70:71]
    v_lshlrev_b64 v[88:89], 16, v[72:73]
    v_lshlrev_b64 v[90:91], 16, v[74:75]
    v_lshlrev_b64 v[92:93], 16, v[76:77]
    v_lshlrev_b64 v[94:95], 16, v[78:79]
    s_waitcnt lgkmcnt(0)
    s_nop 1
    v_mfma_f32_32x32x8_bf16 v[80:95], v[16:17], v[18:19], v[80:95]
    v_mfma_f32_32x32x8_bf16 v[96:111], v[16:17], v[20:21], v[64:79]
    s_nop 15
    v_exp_f32 v112, v80
    v_exp_f32 v113, v81
    v_exp_f32 v114, v82
    v_exp_f32 v115, v83
    v_exp_f32 v116, v84
    v_exp_f32 v117, v85
    v_exp_f32 v118, v86
    v_exp_f32 v119, v87
    v_exp_f32 v120, v88
    v_exp_f32 v121, v89
    v_exp_f32 v122, v90
    v_exp_f32 v123, v91
    v_exp_f32 v124, v92
    v_exp_f32 v125, v93
    v_exp_f32 v126, v94
    v_exp_f32 v127, v95
    v_add_f32 v112, 1.0, v112
    v_add_f32 v113, 1.0, v113
    v_add_f32 v114, 1.0, v114
    v_add_f32 v115, 1.0, v115
    v_add_f32 v116, 1.0, v116
    v_add_f32 v117, 1.0, v117
    v_add_f32 v118, 1.0, v118
    v_add_f32 v119, 1.0, v119
    v_add_f32 v120, 1.0, v120
    v_add_f32 v121, 1.0, v121
    v_add_f32 v122, 1.0, v122
    v_add_f32 v123, 1.0, v123
    v_add_f32 v124, 1.0, v124
    v_add_f32 v125, 1.0, v125
    v_add_f32 v126, 1.0, v126
    v_add_f32 v127, 1.0, v127
    v_rcp_f32 v112, v112
    v_rcp_f32 v113, v113
    v_rcp_f32 v114, v114
    v_rcp_f32 v115, v115
    v_rcp_f32 v116, v116
    v_rcp_f32 v117, v117
    v_rcp_f32 v118, v118
    v_rcp_f32 v119, v119
    v_rcp_f32 v120, v120
    v_rcp_f32 v121, v121
    v_rcp_f32 v122, v122
    v_rcp_f32 v123, v123
    v_rcp_f32 v124, v124
    v_rcp_f32 v125, v125
    v_rcp_f32 v126, v126
    v_rcp_f32 v127, v127
    v_pk_mul_f32 v[24:25], v[80:81], v[112:113]
    v_pk_fma_f32 v[24:25], v[82:83], v[114:115], v[24:25]
    v_pk_fma_f32 v[24:25], v[84:85], v[116:117], v[24:25]
    v_pk_fma_f32 v[24:25], v[86:87], v[118:119], v[24:25]
    v_pk_fma_f32 v[24:25], v[88:89], v[120:121], v[24:25]
    v_pk_fma_f32 v[24:25], v[90:91], v[122:123], v[24:25]
    v_pk_fma_f32 v[24:25], v[92:93], v[124:125], v[24:25]
    v_pk_fma_f32 v[24:25], v[94:95], v[126:127], v[24:25]
    ds_add_f32 v12, v24 offset:256
    ds_add_f32 v13, v25 offset:256
    s_waitcnt lgkmcnt(0)
    v_exp_f32 v112, v96
    v_exp_f32 v113, v97
    v_exp_f32 v114, v98
    v_exp_f32 v115, v99
    v_exp_f32 v116, v100
    v_exp_f32 v117, v101
    v_exp_f32 v118, v102
    v_exp_f32 v119, v103
    v_exp_f32 v120, v104
    v_exp_f32 v121, v105
    v_exp_f32 v122, v106
    v_exp_f32 v123, v107
    v_exp_f32 v124, v108
    v_exp_f32 v125, v109
    v_exp_f32 v126, v110
    v_exp_f32 v127, v111
    v_add_f32 v112, 1.0, v112
    v_add_f32 v113, 1.0, v113
    v_add_f32 v114, 1.0, v114
    v_add_f32 v115, 1.0, v115
    v_add_f32 v116, 1.0, v116
    v_add_f32 v117, 1.0, v117
    v_add_f32 v118, 1.0, v118
    v_add_f32 v119, 1.0, v119
    v_add_f32 v120, 1.0, v120
    v_add_f32 v121, 1.0, v121
    v_add_f32 v122, 1.0, v122
    v_add_f32 v123, 1.0, v123
    v_add_f32 v124, 1.0, v124
    v_add_f32 v125, 1.0, v125
    v_add_f32 v126, 1.0, v126
    v_add_f32 v127, 1.0, v127
    v_rcp_f32 v112, v112
    v_rcp_f32 v113, v113
    v_rcp_f32 v114, v114
    v_rcp_f32 v115, v115
    v_rcp_f32 v116, v116
    v_rcp_f32 v117, v117
    v_rcp_f32 v118, v118
    v_rcp_f32 v119, v119
    v_rcp_f32 v120, v120
    v_rcp_f32 v121, v121
    v_rcp_f32 v122, v122
    v_rcp_f32 v123, v123
    v_rcp_f32 v124, v124
    v_rcp_f32 v125, v125
    v_rcp_f32 v126, v126
    v_rcp_f32 v127, v127
    v_pk_mul_f32 v[24:25], v[96:97], v[112:113]
    v_pk_fma_f32 v[24:25], v[98:99], v[114:115], v[24:25]
    v_pk_fma_f32 v[24:25], v[100:101], v[116:117], v[24:25]
    v_pk_fma_f32 v[24:25], v[102:103], v[118:119], v[24:25]
    v_pk_fma_f32 v[24:25], v[104:105], v[120:121], v[24:25]
    v_pk_fma_f32 v[24:25], v[106:107], v[122:123], v[24:25]
    v_pk_fma_f32 v[24:25], v[108:109], v[124:125], v[24:25]
    v_pk_fma_f32 v[24:25], v[110:111], v[126:127], v[24:25]
    ds_add_f32 v12, v24 offset:384
    ds_add_f32 v13, v25 offset:384
    s_waitcnt lgkmcnt(0)
    s_add_u32 s69, s69, 12
    s_branch L_stile
L_stile_done:
    s_add_u32 s76, s76, 8
    s_add_u32 s68, s68, 96
    s_cmp_lt_u32 s76, s77
    s_cbranch_scc1 L_round
    s_barrier
    s_branch L_epi
.section .rodata,"a"
.p2align 6
.amdhsa_kernel standalone__edge_featured_mpnn_mpnn__graph_kernel
  .amdhsa_next_free_vgpr 168
  .amdhsa_next_free_sgpr 102
  .amdhsa_accum_offset 168
  .amdhsa_group_segment_fixed_size 0
  .amdhsa_kernarg_size 88
  .amdhsa_user_sgpr_count 2
  .amdhsa_user_sgpr_kernarg_segment_ptr 1
  .amdhsa_system_sgpr_workgroup_id_x 1
  .amdhsa_float_denorm_mode_32 3
.end_amdhsa_kernel
```
